```python
import torch

def _softmax(x, axis=-1):
    return torch.softmax(x, dim=axis)
def _gelu(x):
    return torch.nn.functional.gelu(x, approximate="tanh")
def _silu(x):
    return torch.nn.functional.silu(x)
def _sigmoid(x):
    return torch.sigmoid(x)
def _layernorm(x, axis=-1, eps=1e-5):
    m = x.mean(dim=axis, keepdim=True)
    v = x.var(dim=axis, keepdim=True, unbiased=False)
    return (x - m) / torch.sqrt(v + eps)
def _scatter_add(tgt, idx, src, axis=0):
    return tgt.clone().index_add_(axis, idx, src)
def _segment_sum(src, seg, n):
    out = torch.zeros((n,) + src.shape[1:], dtype=src.dtype)
    return out.index_add_(0, seg, src)
def _pad(x, pw):
    flat = tuple(v for pair in reversed(pw) for v in pair)
    return torch.nn.functional.pad(x, flat)

kernel_name = 'concat_heads__softmax_full_mha__linear_kernel_hedgehog__prompt'

def setup_inputs():

    _w = (lambda a: (lambda t: t.to(torch.bfloat16) if t.is_floating_point() else t)(torch.as_tensor(a)))
    def _A_setup():
        B, S, D = 1, 2048, 1024
        return {
            "x": _w((lambda *s: torch.randn(*s, dtype=torch.bfloat16) * 0.2)(B, S, D)),
            "wqkv": _w((lambda *s: torch.randn(*s, dtype=torch.bfloat16) * 0.2)(D, 3 * D)),
            "wo": _w((lambda *s: torch.randn(*s, dtype=torch.bfloat16) * 0.05)(D, D)),
        }
    _A_in = _A_setup()

    def _B_setup():
        B, S, D, H = 1, 2048, 1024, 32
        Dh = D // H
        return {
            "x": _w((lambda *s: torch.randn(*s, dtype=torch.bfloat16) * 0.4)(B, S, D)),
            "wqkv": _w((lambda *s: torch.randn(*s, dtype=torch.bfloat16) * 0.4)(D, 3 * D)),
            "w_phi": _w((lambda *s: torch.randn(*s, dtype=torch.bfloat16) * 0.4)(H, Dh, Dh) * (Dh ** -0.5)),
            "wo": _w((lambda *s: torch.randn(*s, dtype=torch.bfloat16) * 0.05)(D, D)),
        }
    _B_in = _B_setup()

    return {
        "A_x": _A_in["x"],
        "A_wqkv": _A_in["wqkv"],
        "A_wo": _A_in["wo"],
        "B_x": _B_in["x"],
        "B_wqkv": _B_in["wqkv"],
        "B_w_phi": _B_in["w_phi"],
        "B_wo": _B_in["wo"],
    }

def reference(A_x, A_wqkv, A_wo, B_x, B_wqkv, B_w_phi, B_wo):
    def _A_ref(x, wqkv, wo):
        B, S, D = x.shape
        H = 32; Dh = D // H
        qkv = (lambda x, *d: x.permute(*d))((x @ wqkv).reshape(B, S, 3, H, Dh), 2, 0, 3, 1, 4)
        q, k, v = qkv[0], qkv[1], qkv[2]
        scale = Dh ** -0.5
        scores = torch.einsum("bhqd,bhkd->bhqk", q, k) * scale
        p = _softmax(scores, axis=-1)
        o = torch.einsum("bhqk,bhkd->bhqd", p, v)
        return (lambda x, *d: x.permute(*d))(o, 0, 2, 1, 3).reshape(B, S, D) @ wo

    def _B_ref(x, wqkv, w_phi, wo):
        B, S, D = x.shape
        H = 32; Dh = D // H
        qkv = (lambda x, *d: x.permute(*d))((x @ wqkv).reshape(B, S, 3, H, Dh), 2, 0, 3, 1, 4)
        q, k, v = qkv[0], qkv[1], qkv[2]
        pq = torch.einsum("bhsd,hdf->bhsf", q, w_phi)
        pk = torch.einsum("bhsd,hdf->bhsf", k, w_phi)
        phi_q = torch.concatenate([_softmax(pq, axis=-1), _softmax(-pq, axis=-1)], axis=-1)
        phi_k = torch.concatenate([_softmax(pk, axis=-1), _softmax(-pk, axis=-1)], axis=-1)
        kv = torch.einsum("bhsf,bhsd->bhfd", phi_k, v)
        z  = torch.einsum("bhsf->bhf", phi_k)
        num = torch.einsum("bhqf,bhfd->bhqd", phi_q, kv)
        den = torch.einsum("bhqf,bhf->bhq", phi_q, z)[..., None] + 1e-6
        o = num / den
        return (lambda x, *d: x.permute(*d))(o, 0, 2, 1, 3).reshape(B, S, D) @ wo

    a = _A_ref(A_x, A_wqkv, A_wo)
    b = _B_ref(B_x, B_wqkv, B_w_phi, B_wo)
    return torch.concatenate([a, b], axis=-1)
```

```asm
; @launch grid=(256,1,1) block=(512,1,1) lds=163840
.amdgcn_target "amdgcn-amd-amdhsa--gfx950"
.text
.globl concat_heads__softmax_full_mha__linear_kernel_hedgehog__prompt_kernel
.p2align 8
.type concat_heads__softmax_full_mha__linear_kernel_hedgehog__prompt_kernel,@function
concat_heads__softmax_full_mha__linear_kernel_hedgehog__prompt_kernel:
    s_cmp_ge_u32 s2, 256
    s_cbranch_scc1 K1_END
    s_load_dwordx4 s[48:51], s[0:1], 0
    s_load_dwordx4 s[52:55], s[0:1], 24
    s_load_dwordx2 s[56:57], s[0:1], 40
    s_load_dwordx2 s[58:59], s[0:1], 72
    s_load_dwordx2 s[60:61], s[0:1], 64
    s_load_dwordx4 s[64:67], s[0:1], 48
    s_load_dwordx2 s[62:63], s[0:1], 16
    v_and_b32 v1, 63, v0
    v_lshrrev_b32 v11, 6, v0
    s_and_b32 s44, s2, 7
    s_lshr_b32 s45, s2, 3
    v_readfirstlane_b32 s23, v11
    s_lshr_b32 s20, s45, 4
    s_and_b32 s46, s44, 1
    s_lshl_b32 s46, s46, 2
    s_and_b32 s47, s45, 3
    s_add_u32 s21, s46, s47
    s_lshr_b32 s46, s44, 1
    s_lshl_b32 s46, s46, 2
    s_bfe_u32 s47, s45, 0x20002
    s_add_u32 s22, s46, s47
    s_and_b32 s24, s23, 3
    s_lshr_b32 s25, s23, 2
    v_lshrrev_b32 v11, 3, v1
    s_lshl_b32 s44, s24, 3
    v_add_u32 v12, s44, v11
    v_bfe_u32 v13, v12, 1, 3
    v_and_b32 v14, 7, v1
    v_xor_b32 v13, v13, v14
    v_lshlrev_b32 v13, 4, v13
    v_lshl_add_u32 v2, v12, 11, v13
    v_bfe_u32 v13, v11, 1, 1
    v_lshlrev_b32 v13, 2, v13
    v_xor_b32 v13, v13, v14
    s_and_b32 s44, s24, 1
    s_lshl_b32 s44, s44, 1
    v_xor_b32 v13, s44, v13
    v_lshlrev_b32 v13, 4, v13
    v_mul_u32_u24 v3, 6144, v11
    v_add_u32 v3, v3, v13
    s_mul_i32 s37, s24, 49152
    s_cmp_eq_u32 s20, 0
    s_cselect_b32 s44, 0, 2
    s_add_u32 s44, s44, s22
    s_and_b32 s44, s44, 3
    s_and_b32 s45, s22, 12
    s_or_b32 s68, s44, s45
    s_lshl_b32 s29, s68, 7
    s_add_u32 s29, s29, 0
    s_cmp_eq_u32 s20, 0
    s_cselect_b32 s44, 1, 0
    s_add_u32 s44, s44, s22
    s_and_b32 s44, s44, 3
    s_and_b32 s45, s22, 12
    s_or_b32 s69, s44, s45
    s_lshl_b32 s30, s69, 7
    s_add_u32 s30, s30, 2048
    s_cmp_eq_u32 s20, 0
    s_cselect_b32 s44, 2, 0
    s_add_u32 s44, s44, s22
    s_and_b32 s44, s44, 3
    s_and_b32 s45, s22, 12
    s_or_b32 s70, s44, s45
    s_lshl_b32 s31, s70, 7
    s_add_u32 s31, s31, 4096
    s_lshl_b32 s33, s24, 10
    s_add_u32 s40, s33, 98304
    s_mov_b32 s44, 0
    s_lshl_b32 s28, s44, 7
    s_mul_i32 s44, s44, 393216
    s_add_u32 s37, s37, s44
    s_mov_b32 s42, 32
    s_waitcnt lgkmcnt(0)
    s_cmp_eq_u32 s20, 0
    s_cselect_b32 s44, s48, s52
    s_cselect_b32 s45, s49, s53
    s_cselect_b32 s46, s50, s54
    s_cselect_b32 s47, s51, s55
    s_lshl_b32 s26, s21, 19
    s_add_u32 s44, s44, s26
    s_addc_u32 s45, s45, 0
    s_mov_b32 s4, s44
    s_mov_b32 s5, s45
    s_mov_b32 s6, 524288
    s_mov_b32 s7, 0x00020000
    s_mov_b32 s8, s46
    s_mov_b32 s9, s47
    s_mov_b32 s10, 6291456
    s_mov_b32 s11, 0x00020000
    s_mov_b32 s12, s58
    s_mov_b32 s13, s59
    s_mov_b32 s14, 29360128
    s_mov_b32 s15, 0x00020000
    s_mov_b32 s16, s56
    s_mov_b32 s17, s57
    s_mov_b32 s18, 65536
    s_mov_b32 s19, 0x00020000
    s_mov_b32 s96, s60
    s_mov_b32 s97, s61
    s_mov_b32 s98, 256
    s_mov_b32 s99, 0x00020000
    v_mov_b32 v251, 0
    s_bitcmp1_b32 s2, 2
    s_cselect_b32 s62, s64, s62
    s_cselect_b32 s63, s65, s63
    s_mov_b32 s60, s66
    s_mov_b32 s61, s67
    s_cmp_ge_u32 s23, 4
    s_cbranch_scc1 K1_PF_PRO
    s_add_u32 s45, s40, 0
    s_cmp_gt_i32 s42, 0
    s_cselect_b32 s46, s37, 6291456
    s_mov_b32 m0, s45
    s_add_u32 s47, s46, s29
    s_min_u32 s47, s47, 6291456
    buffer_load_dwordx4 v3, s[8:11], s47 offen  lds
    s_add_u32 m0, s45, 4096
    s_add_u32 s47, s46, s30
    s_min_u32 s47, s47, 6291456
    buffer_load_dwordx4 v3, s[8:11], s47 offen  lds
    s_add_u32 m0, s45, 8192
    s_add_u32 s47, s46, s31
    s_min_u32 s47, s47, 6291456
    buffer_load_dwordx4 v3, s[8:11], s47 offen  lds
    s_sub_u32 s42, s42, 1
    s_add_u32 s37, s37, 196608
    s_sub_u32 s47, s37, 6291456
    s_cselect_b32 s37, s37, s47
    s_add_u32 m0, s33, 0
    s_add_u32 s44, s28, 0
    s_min_u32 s44, s44, 524288
    buffer_load_dwordx4 v2, s[4:7], s44 offen  lds
    s_add_u32 m0, s33, 4096
    s_add_u32 s44, s28, 65536
    s_min_u32 s44, s44, 524288
    buffer_load_dwordx4 v2, s[4:7], s44 offen  lds
    s_add_u32 m0, s33, 8192
    s_add_u32 s44, s28, 131072
    s_min_u32 s44, s44, 524288
    buffer_load_dwordx4 v2, s[4:7], s44 offen  lds
    s_add_u32 m0, s33, 12288
    s_add_u32 s44, s28, 196608
    s_min_u32 s44, s44, 524288
    buffer_load_dwordx4 v2, s[4:7], s44 offen  lds
    s_add_u32 m0, s33, 16384
    s_add_u32 s44, s28, 262144
    s_min_u32 s44, s44, 524288
    buffer_load_dwordx4 v2, s[4:7], s44 offen  lds
    s_add_u32 m0, s33, 20480
    s_add_u32 s44, s28, 327680
    s_min_u32 s44, s44, 524288
    buffer_load_dwordx4 v2, s[4:7], s44 offen  lds
    s_add_u32 m0, s33, 24576
    s_add_u32 s44, s28, 393216
    s_min_u32 s44, s44, 524288
    buffer_load_dwordx4 v2, s[4:7], s44 offen  lds
    s_add_u32 m0, s33, 28672
    s_add_u32 s44, s28, 458752
    s_min_u32 s44, s44, 524288
    buffer_load_dwordx4 v2, s[4:7], s44 offen  lds
    s_add_u32 s45, s40, 12288
    s_cmp_gt_i32 s42, 0
    s_cselect_b32 s46, s37, 6291456
    s_mov_b32 m0, s45
    s_add_u32 s47, s46, s29
    s_min_u32 s47, s47, 6291456
    buffer_load_dwordx4 v3, s[8:11], s47 offen  lds
    s_add_u32 m0, s45, 4096
    s_add_u32 s47, s46, s30
    s_min_u32 s47, s47, 6291456
    buffer_load_dwordx4 v3, s[8:11], s47 offen  lds
    s_add_u32 m0, s45, 8192
    s_add_u32 s47, s46, s31
    s_min_u32 s47, s47, 6291456
    buffer_load_dwordx4 v3, s[8:11], s47 offen  lds
    s_sub_u32 s42, s42, 1
    s_add_u32 s37, s37, 196608
    s_sub_u32 s47, s37, 6291456
    s_cselect_b32 s37, s37, s47
    s_add_u32 s28, s28, 128
    s_and_b32 s28, s28, 2047
    s_add_u32 s33, s33, 32768
    s_add_u32 s45, s40, 24576
    s_cmp_gt_i32 s42, 0
    s_cselect_b32 s46, s37, 6291456
    s_mov_b32 m0, s45
    s_add_u32 s47, s46, s29
    s_min_u32 s47, s47, 6291456
    buffer_load_dwordx4 v3, s[8:11], s47 offen  lds
    s_add_u32 m0, s45, 4096
    s_add_u32 s47, s46, s30
    s_min_u32 s47, s47, 6291456
    buffer_load_dwordx4 v3, s[8:11], s47 offen  lds
    s_add_u32 m0, s45, 8192
    s_add_u32 s47, s46, s31
    s_min_u32 s47, s47, 6291456
    buffer_load_dwordx4 v3, s[8:11], s47 offen  lds
    s_sub_u32 s42, s42, 1
    s_add_u32 s37, s37, 196608
    s_sub_u32 s47, s37, 6291456
    s_cselect_b32 s37, s37, s47
    s_add_u32 m0, s33, 0
    s_add_u32 s44, s28, 0
    s_min_u32 s44, s44, 524288
    buffer_load_dwordx4 v2, s[4:7], s44 offen  lds
    s_add_u32 m0, s33, 4096
    s_add_u32 s44, s28, 65536
    s_min_u32 s44, s44, 524288
    buffer_load_dwordx4 v2, s[4:7], s44 offen  lds
    s_add_u32 m0, s33, 8192
    s_add_u32 s44, s28, 131072
    s_min_u32 s44, s44, 524288
    buffer_load_dwordx4 v2, s[4:7], s44 offen  lds
    s_add_u32 m0, s33, 12288
    s_add_u32 s44, s28, 196608
    s_min_u32 s44, s44, 524288
    buffer_load_dwordx4 v2, s[4:7], s44 offen  lds
    s_add_u32 m0, s33, 16384
    s_add_u32 s44, s28, 262144
    s_min_u32 s44, s44, 524288
    buffer_load_dwordx4 v2, s[4:7], s44 offen  lds
    s_add_u32 m0, s33, 20480
    s_add_u32 s44, s28, 327680
    s_min_u32 s44, s44, 524288
    buffer_load_dwordx4 v2, s[4:7], s44 offen  lds
    s_add_u32 m0, s33, 24576
    s_add_u32 s44, s28, 393216
    s_min_u32 s44, s44, 524288
    buffer_load_dwordx4 v2, s[4:7], s44 offen  lds
    s_add_u32 m0, s33, 28672
    s_add_u32 s44, s28, 458752
    s_min_u32 s44, s44, 524288
    buffer_load_dwordx4 v2, s[4:7], s44 offen  lds
    s_add_u32 s45, s40, 36864
    s_cmp_gt_i32 s42, 0
    s_cselect_b32 s46, s37, 6291456
    s_mov_b32 m0, s45
    s_add_u32 s47, s46, s29
    s_min_u32 s47, s47, 6291456
    buffer_load_dwordx4 v3, s[8:11], s47 offen  lds
    s_add_u32 m0, s45, 4096
    s_add_u32 s47, s46, s30
    s_min_u32 s47, s47, 6291456
    buffer_load_dwordx4 v3, s[8:11], s47 offen  lds
    s_add_u32 m0, s45, 8192
    s_add_u32 s47, s46, s31
    s_min_u32 s47, s47, 6291456
    buffer_load_dwordx4 v3, s[8:11], s47 offen  lds
    s_sub_u32 s42, s42, 1
    s_add_u32 s37, s37, 196608
    s_sub_u32 s47, s37, 6291456
    s_cselect_b32 s37, s37, s47
    s_add_u32 s28, s28, 128
    s_and_b32 s28, s28, 2047
    s_add_u32 s33, s33, 32768
    s_branch K1_PRO2
K1_PF_PRO:
    s_mov_b32 s41, -1
    v_lshlrev_b32 v11, 4, v1
    s_lshl_b32 s44, s22, 12
    s_lshl_b32 s45, s24, 10
    s_add_u32 s44, s44, s45
    s_add_u32 m0, s45, 159744
    s_nop 0
    buffer_load_dwordx4 v11, s[16:19], s44 offen lds
    s_cmp_eq_u32 s23, 5
    s_cbranch_scc1 K1_CPF
    s_add_u32 s46, s2, s24
    s_cmp_eq_u32 s46, 0
    s_cbranch_scc1 K1_TOK
    buffer_load_dwordx4 v11, s[16:19], s44 offen lds
    s_branch K1_TOKX
K1_CPF:
    s_getpc_b64 s[46:47]
    s_lshr_b32 s44, s2, 3
    s_lshl_b32 s44, s44, 10
    v_add_u32 v12, s44, v11
    v_min_u32 v12, CODE_END-K1_CPF-32, v12
    global_load_dwordx4 v[252:255], v12, s[46:47]
    s_branch K1_TOKX
K1_TOK:
    s_memrealtime s[46:47]
    v_mov_b32 v12, 0
    s_waitcnt lgkmcnt(0)
    s_or_b32 s46, s46, 1
    v_mov_b32 v250, s46
    s_mov_b64 exec, 1
    buffer_store_dword v250, v12, s[96:99], 0 offen sc1
    s_mov_b64 exec, -1
K1_TOKX:
K1_PRO2:
    v_and_b32 v11, 15, v1
    v_lshrrev_b32 v12, 4, v1
    v_lshrrev_b32 v13, 1, v11
    v_xor_b32 v13, v13, v12
    v_lshlrev_b32 v13, 4, v13
    v_lshl_add_u32 v4, v11, 7, v13
    s_lshl_b32 s44, s24, 13
    v_add_u32 v4, s44, v4
    v_bfe_u32 v11, v1, 2, 2
    v_lshl_add_u32 v13, v12, 3, v11
    v_lshlrev_b32 v5, 7, v13
    v_bfe_u32 v13, v1, 1, 1
    s_lshl_b32 s44, s25, 2
    v_add_u32 v13, s44, v13
    v_lshrrev_b32 v14, 1, v11
    v_lshlrev_b32 v14, 2, v14
    v_xor_b32 v13, v13, v14
    v_and_b32 v14, 1, v12
    v_lshlrev_b32 v14, 1, v14
    v_xor_b32 v13, v13, v14
    v_lshl_add_u32 v5, v13, 4, v5
    v_and_b32 v13, 1, v1
    v_lshl_add_u32 v5, v13, 3, v5
    v_add_u32 v5, 98304, v5
    s_and_b32 s44, s2, 7
    s_lshl_b32 s44, s44, 1
    s_bfe_u32 s45, s2, 0x10004
    s_add_u32 s44, s44, s45
    s_and_b32 s45, s44, 12
    s_sub_u32 s46, s44, 1
    s_and_b32 s46, s46, 3
    s_or_b32 s46, s46, s45
    s_sub_u32 s47, s44, 2
    s_and_b32 s47, s47, 3
    s_or_b32 s47, s47, s45
    s_lshl_b32 s44, s44, 3
    s_lshr_b32 s45, s2, 5
    s_add_u32 s44, s44, s45
    v_and_b32 v11, 7, v1
    v_mov_b32 v12, s47
    v_mov_b32 v247, s46
    v_cmp_gt_u32 vcc, 8, v1
    s_nop 1
    v_cndmask_b32 v247, v12, v247, vcc
    v_lshl_add_u32 v247, v247, 3, v11
    v_mov_b32 v12, s44
    v_cmp_gt_u32 vcc, 16, v1
    s_nop 1
    v_cndmask_b32 v247, v12, v247, vcc
    v_cmp_gt_u32 vcc, 2, v11
    s_nop 1
    v_cndmask_b32 v248, v12, v247, vcc
    s_and_b32 s44, s2, 7
    s_lshl_b32 s44, s44, 10
    s_add_u32 s44, s44, 19927040
    v_lshl_add_u32 v247, v247, 2, s44
    v_lshl_add_u32 v248, v248, 2, s44
    v_mov_b32 v16, 0
    v_mov_b32 v17, 0
    v_mov_b32 v18, 0
    v_mov_b32 v19, 0
    v_mov_b32 v20, 0
    v_mov_b32 v21, 0
    v_mov_b32 v22, 0
    v_mov_b32 v23, 0
    v_mov_b32 v24, 0
    v_mov_b32 v25, 0
    v_mov_b32 v26, 0
    v_mov_b32 v27, 0
    v_mov_b32 v28, 0
    v_mov_b32 v29, 0
    v_mov_b32 v30, 0
    v_mov_b32 v31, 0
    v_mov_b32 v32, 0
    v_mov_b32 v33, 0
    v_mov_b32 v34, 0
    v_mov_b32 v35, 0
    v_mov_b32 v36, 0
    v_mov_b32 v37, 0
    v_mov_b32 v38, 0
    v_mov_b32 v39, 0
    v_mov_b32 v40, 0
    v_mov_b32 v41, 0
    v_mov_b32 v42, 0
    v_mov_b32 v43, 0
    v_mov_b32 v44, 0
    v_mov_b32 v45, 0
    v_mov_b32 v46, 0
    v_mov_b32 v47, 0
    v_mov_b32 v48, 0
    v_mov_b32 v49, 0
    v_mov_b32 v50, 0
    v_mov_b32 v51, 0
    v_mov_b32 v52, 0
    v_mov_b32 v53, 0
    v_mov_b32 v54, 0
    v_mov_b32 v55, 0
    v_mov_b32 v56, 0
    v_mov_b32 v57, 0
    v_mov_b32 v58, 0
    v_mov_b32 v59, 0
    v_mov_b32 v60, 0
    v_mov_b32 v61, 0
    v_mov_b32 v62, 0
    v_mov_b32 v63, 0
    v_mov_b32 v64, 0
    v_mov_b32 v65, 0
    v_mov_b32 v66, 0
    v_mov_b32 v67, 0
    v_mov_b32 v68, 0
    v_mov_b32 v69, 0
    v_mov_b32 v70, 0
    v_mov_b32 v71, 0
    v_mov_b32 v72, 0
    v_mov_b32 v73, 0
    v_mov_b32 v74, 0
    v_mov_b32 v75, 0
    v_mov_b32 v76, 0
    v_mov_b32 v77, 0
    v_mov_b32 v78, 0
    v_mov_b32 v79, 0
    v_mov_b32 v80, 0
    v_mov_b32 v81, 0
    v_mov_b32 v82, 0
    v_mov_b32 v83, 0
    v_mov_b32 v84, 0
    v_mov_b32 v85, 0
    v_mov_b32 v86, 0
    v_mov_b32 v87, 0
    v_mov_b32 v88, 0
    v_mov_b32 v89, 0
    v_mov_b32 v90, 0
    v_mov_b32 v91, 0
    v_mov_b32 v92, 0
    v_mov_b32 v93, 0
    v_mov_b32 v94, 0
    v_mov_b32 v95, 0
    v_mov_b32 v96, 0
    v_mov_b32 v97, 0
    v_mov_b32 v98, 0
    v_mov_b32 v99, 0
    v_mov_b32 v100, 0
    v_mov_b32 v101, 0
    v_mov_b32 v102, 0
    v_mov_b32 v103, 0
    v_mov_b32 v104, 0
    v_mov_b32 v105, 0
    v_mov_b32 v106, 0
    v_mov_b32 v107, 0
    v_mov_b32 v108, 0
    v_mov_b32 v109, 0
    v_mov_b32 v110, 0
    v_mov_b32 v111, 0
    s_mov_b32 s32, 0
    s_mov_b32 s34, 0
    s_mov_b32 s35, 49152
    s_mov_b32 s36, 36864
    v_mov_b32 v6, v4
    v_xor_b32 v7, 64, v4
    v_mov_b32 v8, v5
    v_xor_b32 v9, 32, v5
    s_mov_b32 s26, 0
    s_cmp_ge_u32 s23, 4
    s_cbranch_scc1 K1_P
    s_waitcnt vmcnt(14)
    s_barrier
    ds_read_b128 v[112:115], v6 offset:0
    ds_read_b64_tr_b16 v[144:145], v8 offset:0
    ds_read_b64_tr_b16 v[146:147], v8 offset:512
    ds_read_b128 v[116:119], v6 offset:2048
    ds_read_b128 v[120:123], v6 offset:4096
    ds_read_b128 v[124:127], v6 offset:6144
    ds_read_b64_tr_b16 v[148:149], v9 offset:0
    ds_read_b64_tr_b16 v[150:151], v9 offset:512
    ds_read_b64_tr_b16 v[152:153], v8 offset:4096
    ds_read_b64_tr_b16 v[154:155], v8 offset:4608
    s_add_u32 s45, s40, s35
    s_cmp_gt_i32 s42, 0
    s_cselect_b32 s46, s37, 6291456
    s_mov_b32 m0, s45
    s_add_u32 s47, s46, s29
    s_min_u32 s47, s47, 6291456
    buffer_load_dwordx4 v3, s[8:11], s47 offen  lds
    s_add_u32 m0, s45, 4096
    s_add_u32 s47, s46, s30
    s_min_u32 s47, s47, 6291456
    buffer_load_dwordx4 v3, s[8:11], s47 offen  lds
    s_add_u32 m0, s45, 8192
    s_add_u32 s47, s46, s31
    s_min_u32 s47, s47, 6291456
    buffer_load_dwordx4 v3, s[8:11], s47 offen  lds
    s_sub_u32 s42, s42, 1
    s_add_u32 s37, s37, 196608
    s_sub_u32 s47, s37, 6291456
    s_cselect_b32 s37, s37, s47
    .p2align 6
K1_LOOP_L:
    s_waitcnt lgkmcnt(4)
    v_mfma_f32_16x16x32_bf16 v[16:19], v[144:147], v[112:115], v[16:19]
    ds_read_b64_tr_b16 v[156:157], v9 offset:4096
    v_mfma_f32_16x16x32_bf16 v[20:23], v[144:147], v[116:119], v[20:23]
    ds_read_b64_tr_b16 v[158:159], v9 offset:4608
    v_mfma_f32_16x16x32_bf16 v[24:27], v[144:147], v[120:123], v[24:27]
    ds_read_b64_tr_b16 v[160:161], v8 offset:8192
    s_add_u32 m0, s33, 0
    s_add_u32 s44, s28, 0
    s_min_u32 s44, s44, 524288
    buffer_load_dwordx4 v2, s[4:7], s44 offen  lds
    v_mfma_f32_16x16x32_bf16 v[28:31], v[144:147], v[124:127], v[28:31]
    ds_read_b64_tr_b16 v[162:163], v8 offset:8704
    s_waitcnt lgkmcnt(6)
    v_mfma_f32_16x16x32_bf16 v[32:35], v[148:151], v[112:115], v[32:35]
    ds_read_b64_tr_b16 v[164:165], v9 offset:8192
    s_add_u32 m0, s33, 4096
    s_add_u32 s44, s28, 65536
    s_min_u32 s44, s44, 524288
    buffer_load_dwordx4 v2, s[4:7], s44 offen  lds
    v_mfma_f32_16x16x32_bf16 v[36:39], v[148:151], v[116:119], v[36:39]
    ds_read_b64_tr_b16 v[166:167], v9 offset:8704
    s_add_u32 m0, s33, 8192
    s_add_u32 s44, s28, 131072
    s_min_u32 s44, s44, 524288
    buffer_load_dwordx4 v2, s[4:7], s44 offen  lds
    v_mfma_f32_16x16x32_bf16 v[40:43], v[148:151], v[120:123], v[40:43]
    s_add_u32 m0, s33, 12288
    s_add_u32 s44, s28, 196608
    s_min_u32 s44, s44, 524288
    buffer_load_dwordx4 v2, s[4:7], s44 offen  lds
    v_mfma_f32_16x16x32_bf16 v[44:47], v[148:151], v[124:127], v[44:47]
    s_mov_b32 s36, s35
    s_mov_b32 s35, s34
    s_waitcnt lgkmcnt(6)
    v_mfma_f32_16x16x32_bf16 v[48:51], v[152:155], v[112:115], v[48:51]
    s_add_u32 s34, s34, 12288
    s_cmp_eq_u32 s34, 61440
    v_mfma_f32_16x16x32_bf16 v[52:55], v[152:155], v[116:119], v[52:55]
    s_cselect_b32 s34, 0, s34
    v_add_u32 v8, s34, v5
    v_mfma_f32_16x16x32_bf16 v[56:59], v[152:155], v[120:123], v[56:59]
    v_xor_b32 v9, 32, v8
    v_mfma_f32_16x16x32_bf16 v[60:63], v[152:155], v[124:127], v[60:63]
    s_waitcnt vmcnt(14) lgkmcnt(0)
    s_barrier
    v_mfma_f32_16x16x32_bf16 v[64:67], v[156:159], v[112:115], v[64:67]
    ds_read_b128 v[128:131], v7 offset:0
    v_mfma_f32_16x16x32_bf16 v[68:71], v[156:159], v[116:119], v[68:71]
    ds_read_b64_tr_b16 v[144:145], v8 offset:0
    v_mfma_f32_16x16x32_bf16 v[72:75], v[156:159], v[120:123], v[72:75]
    ds_read_b64_tr_b16 v[146:147], v8 offset:512
    v_mfma_f32_16x16x32_bf16 v[76:79], v[156:159], v[124:127], v[76:79]
    ds_read_b128 v[132:135], v7 offset:2048
    v_mfma_f32_16x16x32_bf16 v[80:83], v[112:115], v[160:163], v[80:83]
    ds_read_b128 v[136:139], v7 offset:4096
    v_mfma_f32_16x16x32_bf16 v[84:87], v[116:119], v[160:163], v[84:87]
    ds_read_b128 v[140:143], v7 offset:6144
    v_mfma_f32_16x16x32_bf16 v[88:91], v[120:123], v[160:163], v[88:91]
    ds_read_b64_tr_b16 v[148:149], v9 offset:0
    v_mfma_f32_16x16x32_bf16 v[92:95], v[124:127], v[160:163], v[92:95]
    ds_read_b64_tr_b16 v[150:151], v9 offset:512
    s_add_u32 s45, s40, s35
    s_cmp_gt_i32 s42, 0
    s_cselect_b32 s46, s37, 6291456
    s_mov_b32 m0, s45
    s_add_u32 s47, s46, s29
    s_min_u32 s47, s47, 6291456
    buffer_load_dwordx4 v3, s[8:11], s47 offen  lds
    v_mfma_f32_16x16x32_bf16 v[96:99], v[112:115], v[164:167], v[96:99]
    ds_read_b64_tr_b16 v[152:153], v8 offset:4096
    v_mfma_f32_16x16x32_bf16 v[100:103], v[116:119], v[164:167], v[100:103]
    ds_read_b64_tr_b16 v[154:155], v8 offset:4608
    s_add_u32 m0, s45, 4096
    s_add_u32 s47, s46, s30
    s_min_u32 s47, s47, 6291456
    buffer_load_dwordx4 v3, s[8:11], s47 offen  lds
    v_mfma_f32_16x16x32_bf16 v[104:107], v[120:123], v[164:167], v[104:107]
    s_add_u32 m0, s45, 8192
    s_add_u32 s47, s46, s31
    s_min_u32 s47, s47, 6291456
    buffer_load_dwordx4 v3, s[8:11], s47 offen  lds
    s_sub_u32 s42, s42, 1
    s_add_u32 s37, s37, 196608
    s_sub_u32 s47, s37, 6291456
    s_cselect_b32 s37, s37, s47
    v_mfma_f32_16x16x32_bf16 v[108:111], v[124:127], v[164:167], v[108:111]
    s_waitcnt lgkmcnt(4)
    v_mfma_f32_16x16x32_bf16 v[16:19], v[144:147], v[128:131], v[16:19]
    ds_read_b64_tr_b16 v[156:157], v9 offset:4096
    v_mfma_f32_16x16x32_bf16 v[20:23], v[144:147], v[132:135], v[20:23]
    ds_read_b64_tr_b16 v[158:159], v9 offset:4608
    v_mfma_f32_16x16x32_bf16 v[24:27], v[144:147], v[136:139], v[24:27]
    ds_read_b64_tr_b16 v[160:161], v8 offset:8192
    s_add_u32 m0, s33, 16384
    s_add_u32 s44, s28, 262144
    s_min_u32 s44, s44, 524288
    buffer_load_dwordx4 v2, s[4:7], s44 offen  lds
    v_mfma_f32_16x16x32_bf16 v[28:31], v[144:147], v[140:143], v[28:31]
    ds_read_b64_tr_b16 v[162:163], v8 offset:8704
    s_waitcnt lgkmcnt(6)
    v_mfma_f32_16x16x32_bf16 v[32:35], v[148:151], v[128:131], v[32:35]
    ds_read_b64_tr_b16 v[164:165], v9 offset:8192
    s_add_u32 m0, s33, 20480
    s_add_u32 s44, s28, 327680
    s_min_u32 s44, s44, 524288
    buffer_load_dwordx4 v2, s[4:7], s44 offen  lds
    v_mfma_f32_16x16x32_bf16 v[36:39], v[148:151], v[132:135], v[36:39]
    ds_read_b64_tr_b16 v[166:167], v9 offset:8704
    s_add_u32 m0, s33, 24576
    s_add_u32 s44, s28, 393216
    s_min_u32 s44, s44, 524288
    buffer_load_dwordx4 v2, s[4:7], s44 offen  lds
    v_mfma_f32_16x16x32_bf16 v[40:43], v[148:151], v[136:139], v[40:43]
    s_add_u32 m0, s33, 28672
    s_add_u32 s44, s28, 458752
    s_min_u32 s44, s44, 524288
    buffer_load_dwordx4 v2, s[4:7], s44 offen  lds
    v_mfma_f32_16x16x32_bf16 v[44:47], v[148:151], v[140:143], v[44:47]
    s_mov_b32 s36, s35
    s_mov_b32 s35, s34
    s_add_u32 s34, s34, 12288
    s_cmp_eq_u32 s34, 61440
    s_cselect_b32 s34, 0, s34
    s_waitcnt lgkmcnt(6)
    v_mfma_f32_16x16x32_bf16 v[48:51], v[152:155], v[128:131], v[48:51]
    v_add_u32 v8, s34, v5
    v_xor_b32 v9, 32, v8
    s_lshl_b32 s44, s24, 10
    s_add_u32 s33, s32, s44
    s_add_u32 s32, s32, 32768
    v_mfma_f32_16x16x32_bf16 v[52:55], v[152:155], v[132:135], v[52:55]
    s_cmp_eq_u32 s32, 98304
    s_cselect_b32 s32, 0, s32
    v_add_u32 v6, s32, v4
    v_xor_b32 v7, 64, v6
    s_add_u32 s44, s28, 128
    v_mfma_f32_16x16x32_bf16 v[56:59], v[152:155], v[136:139], v[56:59]
    s_and_b32 s44, s44, 2047
    s_cmp_ge_u32 s26, 13
    s_cselect_b32 s28, 524288, s44
    s_add_u32 s26, s26, 1
    v_mfma_f32_16x16x32_bf16 v[60:63], v[152:155], v[140:143], v[60:63]
    s_waitcnt vmcnt(14) lgkmcnt(0)
    s_barrier
    v_mfma_f32_16x16x32_bf16 v[64:67], v[156:159], v[128:131], v[64:67]
    ds_read_b128 v[112:115], v6 offset:0
    v_mfma_f32_16x16x32_bf16 v[68:71], v[156:159], v[132:135], v[68:71]
    ds_read_b64_tr_b16 v[144:145], v8 offset:0
    v_mfma_f32_16x16x32_bf16 v[72:75], v[156:159], v[136:139], v[72:75]
    ds_read_b64_tr_b16 v[146:147], v8 offset:512
    v_mfma_f32_16x16x32_bf16 v[76:79], v[156:159], v[140:143], v[76:79]
    ds_read_b128 v[116:119], v6 offset:2048
    v_mfma_f32_16x16x32_bf16 v[80:83], v[128:131], v[160:163], v[80:83]
    ds_read_b128 v[120:123], v6 offset:4096
    v_mfma_f32_16x16x32_bf16 v[84:87], v[132:135], v[160:163], v[84:87]
    ds_read_b128 v[124:127], v6 offset:6144
    v_mfma_f32_16x16x32_bf16 v[88:91], v[136:139], v[160:163], v[88:91]
    ds_read_b64_tr_b16 v[148:149], v9 offset:0
    v_mfma_f32_16x16x32_bf16 v[92:95], v[140:143], v[160:163], v[92:95]
    ds_read_b64_tr_b16 v[150:151], v9 offset:512
    s_add_u32 s45, s40, s35
    s_cmp_gt_i32 s42, 0
    s_cselect_b32 s46, s37, 6291456
    s_mov_b32 m0, s45
    s_add_u32 s47, s46, s29
    s_min_u32 s47, s47, 6291456
    buffer_load_dwordx4 v3, s[8:11], s47 offen  lds
    v_mfma_f32_16x16x32_bf16 v[96:99], v[128:131], v[164:167], v[96:99]
    ds_read_b64_tr_b16 v[152:153], v8 offset:4096
    v_mfma_f32_16x16x32_bf16 v[100:103], v[132:135], v[164:167], v[100:103]
    ds_read_b64_tr_b16 v[154:155], v8 offset:4608
    s_add_u32 m0, s45, 4096
    s_add_u32 s47, s46, s30
    s_min_u32 s47, s47, 6291456
    buffer_load_dwordx4 v3, s[8:11], s47 offen  lds
    v_mfma_f32_16x16x32_bf16 v[104:107], v[136:139], v[164:167], v[104:107]
    s_add_u32 m0, s45, 8192
    s_add_u32 s47, s46, s31
    s_min_u32 s47, s47, 6291456
    buffer_load_dwordx4 v3, s[8:11], s47 offen  lds
    s_sub_u32 s42, s42, 1
    s_add_u32 s37, s37, 196608
    s_sub_u32 s47, s37, 6291456
    s_cselect_b32 s37, s37, s47
    v_mfma_f32_16x16x32_bf16 v[108:111], v[140:143], v[164:167], v[108:111]
    s_cmp_lt_u32 s26, 16
    s_cbranch_scc1 K1_LOOP_L
    s_branch K1_EPI
K1_P:
    s_waitcnt vmcnt(1)
    s_barrier
    ds_read_b128 v[112:115], v6 offset:0
    ds_read_b64_tr_b16 v[144:145], v8 offset:0
    ds_read_b64_tr_b16 v[146:147], v8 offset:512
    ds_read_b128 v[116:119], v6 offset:2048
    ds_read_b128 v[120:123], v6 offset:4096
    ds_read_b128 v[124:127], v6 offset:6144
    ds_read_b64_tr_b16 v[148:149], v9 offset:0
    ds_read_b64_tr_b16 v[150:151], v9 offset:512
    ds_read_b64_tr_b16 v[152:153], v8 offset:4096
    ds_read_b64_tr_b16 v[154:155], v8 offset:4608
    .p2align 6
K1_LOOP_P:
    s_waitcnt lgkmcnt(4)
    v_mfma_f32_16x16x32_bf16 v[16:19], v[144:147], v[112:115], v[16:19]
    ds_read_b64_tr_b16 v[156:157], v9 offset:4096
    v_mfma_f32_16x16x32_bf16 v[20:23], v[144:147], v[116:119], v[20:23]
    ds_read_b64_tr_b16 v[158:159], v9 offset:4608
    v_mfma_f32_16x16x32_bf16 v[24:27], v[144:147], v[120:123], v[24:27]
    ds_read_b64_tr_b16 v[160:161], v8 offset:8192
    v_mfma_f32_16x16x32_bf16 v[28:31], v[144:147], v[124:127], v[28:31]
    ds_read_b64_tr_b16 v[162:163], v8 offset:8704
    s_waitcnt lgkmcnt(6)
    v_mfma_f32_16x16x32_bf16 v[32:35], v[148:151], v[112:115], v[32:35]
    ds_read_b64_tr_b16 v[164:165], v9 offset:8192
    v_mfma_f32_16x16x32_bf16 v[36:39], v[148:151], v[116:119], v[36:39]
    ds_read_b64_tr_b16 v[166:167], v9 offset:8704
    v_mfma_f32_16x16x32_bf16 v[40:43], v[148:151], v[120:123], v[40:43]
    v_mfma_f32_16x16x32_bf16 v[44:47], v[148:151], v[124:127], v[44:47]
    s_mov_b32 s36, s35
    s_mov_b32 s35, s34
    s_waitcnt lgkmcnt(6)
    v_mfma_f32_16x16x32_bf16 v[48:51], v[152:155], v[112:115], v[48:51]
    s_add_u32 s34, s34, 12288
    s_cmp_eq_u32 s34, 61440
    v_mfma_f32_16x16x32_bf16 v[52:55], v[152:155], v[116:119], v[52:55]
    s_cselect_b32 s34, 0, s34
    v_add_u32 v8, s34, v5
    v_mfma_f32_16x16x32_bf16 v[56:59], v[152:155], v[120:123], v[56:59]
    v_xor_b32 v9, 32, v8
    v_mfma_f32_16x16x32_bf16 v[60:63], v[152:155], v[124:127], v[60:63]
    s_waitcnt lgkmcnt(0)
    s_barrier
    v_mfma_f32_16x16x32_bf16 v[64:67], v[156:159], v[112:115], v[64:67]
    ds_read_b128 v[128:131], v7 offset:0
    v_mfma_f32_16x16x32_bf16 v[68:71], v[156:159], v[116:119], v[68:71]
    ds_read_b64_tr_b16 v[144:145], v8 offset:0
    v_mfma_f32_16x16x32_bf16 v[72:75], v[156:159], v[120:123], v[72:75]
    ds_read_b64_tr_b16 v[146:147], v8 offset:512
    v_mfma_f32_16x16x32_bf16 v[76:79], v[156:159], v[124:127], v[76:79]
    ds_read_b128 v[132:135], v7 offset:2048
    v_mfma_f32_16x16x32_bf16 v[80:83], v[112:115], v[160:163], v[80:83]
    ds_read_b128 v[136:139], v7 offset:4096
    v_mfma_f32_16x16x32_bf16 v[84:87], v[116:119], v[160:163], v[84:87]
    ds_read_b128 v[140:143], v7 offset:6144
    v_mfma_f32_16x16x32_bf16 v[88:91], v[120:123], v[160:163], v[88:91]
    ds_read_b64_tr_b16 v[148:149], v9 offset:0
    v_mfma_f32_16x16x32_bf16 v[92:95], v[124:127], v[160:163], v[92:95]
    ds_read_b64_tr_b16 v[150:151], v9 offset:512
    v_mfma_f32_16x16x32_bf16 v[96:99], v[112:115], v[164:167], v[96:99]
    ds_read_b64_tr_b16 v[152:153], v8 offset:4096
    v_mfma_f32_16x16x32_bf16 v[100:103], v[116:119], v[164:167], v[100:103]
    ds_read_b64_tr_b16 v[154:155], v8 offset:4608
    v_mfma_f32_16x16x32_bf16 v[104:107], v[120:123], v[164:167], v[104:107]
    v_mfma_f32_16x16x32_bf16 v[108:111], v[124:127], v[164:167], v[108:111]
    s_waitcnt lgkmcnt(4)
    v_mfma_f32_16x16x32_bf16 v[16:19], v[144:147], v[128:131], v[16:19]
    ds_read_b64_tr_b16 v[156:157], v9 offset:4096
    v_mfma_f32_16x16x32_bf16 v[20:23], v[144:147], v[132:135], v[20:23]
    ds_read_b64_tr_b16 v[158:159], v9 offset:4608
    v_mfma_f32_16x16x32_bf16 v[24:27], v[144:147], v[136:139], v[24:27]
    ds_read_b64_tr_b16 v[160:161], v8 offset:8192
    v_mfma_f32_16x16x32_bf16 v[28:31], v[144:147], v[140:143], v[28:31]
    ds_read_b64_tr_b16 v[162:163], v8 offset:8704
    s_waitcnt lgkmcnt(6)
    v_mfma_f32_16x16x32_bf16 v[32:35], v[148:151], v[128:131], v[32:35]
    ds_read_b64_tr_b16 v[164:165], v9 offset:8192
    v_mfma_f32_16x16x32_bf16 v[36:39], v[148:151], v[132:135], v[36:39]
    ds_read_b64_tr_b16 v[166:167], v9 offset:8704
    v_mfma_f32_16x16x32_bf16 v[40:43], v[148:151], v[136:139], v[40:43]
    v_mfma_f32_16x16x32_bf16 v[44:47], v[148:151], v[140:143], v[44:47]
    s_mov_b32 s36, s35
    s_mov_b32 s35, s34
    s_add_u32 s34, s34, 12288
    s_cmp_eq_u32 s34, 61440
    s_cselect_b32 s34, 0, s34
    s_waitcnt lgkmcnt(6)
    v_mfma_f32_16x16x32_bf16 v[48:51], v[152:155], v[128:131], v[48:51]
    v_add_u32 v8, s34, v5
    v_xor_b32 v9, 32, v8
    s_lshl_b32 s44, s24, 10
    s_add_u32 s33, s32, s44
    s_add_u32 s32, s32, 32768
    v_mfma_f32_16x16x32_bf16 v[52:55], v[152:155], v[132:135], v[52:55]
    s_cmp_eq_u32 s32, 98304
    s_cselect_b32 s32, 0, s32
    v_add_u32 v6, s32, v4
    v_xor_b32 v7, 64, v6
    s_add_u32 s44, s28, 128
    v_mfma_f32_16x16x32_bf16 v[56:59], v[152:155], v[136:139], v[56:59]
    s_and_b32 s44, s44, 2047
    s_cmp_ge_u32 s26, 13
    s_cselect_b32 s28, 524288, s44
    s_add_u32 s26, s26, 1
    v_mfma_f32_16x16x32_bf16 v[60:63], v[152:155], v[140:143], v[60:63]
    s_waitcnt lgkmcnt(0)
    s_barrier
    v_mfma_f32_16x16x32_bf16 v[64:67], v[156:159], v[128:131], v[64:67]
    ds_read_b128 v[112:115], v6 offset:0
    v_mfma_f32_16x16x32_bf16 v[68:71], v[156:159], v[132:135], v[68:71]
    ds_read_b64_tr_b16 v[144:145], v8 offset:0
    v_mfma_f32_16x16x32_bf16 v[72:75], v[156:159], v[136:139], v[72:75]
    ds_read_b64_tr_b16 v[146:147], v8 offset:512
    v_mfma_f32_16x16x32_bf16 v[76:79], v[156:159], v[140:143], v[76:79]
    ds_read_b128 v[116:119], v6 offset:2048
    v_mfma_f32_16x16x32_bf16 v[80:83], v[128:131], v[160:163], v[80:83]
    ds_read_b128 v[120:123], v6 offset:4096
    v_mfma_f32_16x16x32_bf16 v[84:87], v[132:135], v[160:163], v[84:87]
    ds_read_b128 v[124:127], v6 offset:6144
    v_mfma_f32_16x16x32_bf16 v[88:91], v[136:139], v[160:163], v[88:91]
    ds_read_b64_tr_b16 v[148:149], v9 offset:0
    v_mfma_f32_16x16x32_bf16 v[92:95], v[140:143], v[160:163], v[92:95]
    ds_read_b64_tr_b16 v[150:151], v9 offset:512
    v_mfma_f32_16x16x32_bf16 v[96:99], v[128:131], v[164:167], v[96:99]
    ds_read_b64_tr_b16 v[152:153], v8 offset:4096
    v_mfma_f32_16x16x32_bf16 v[100:103], v[132:135], v[164:167], v[100:103]
    ds_read_b64_tr_b16 v[154:155], v8 offset:4608
    v_mfma_f32_16x16x32_bf16 v[104:107], v[136:139], v[164:167], v[104:107]
    v_mfma_f32_16x16x32_bf16 v[108:111], v[140:143], v[164:167], v[108:111]
    s_cmp_lt_u32 s26, 16
    s_cbranch_scc1 K1_LOOP_P
    buffer_load_dword v250, v251, s[96:99], 0 offen sc1
K1_EPI:
    s_nop 15
    s_lshl_b32 s64, s69, 1
    s_add_u32 s64, s64, s25
    s_lshl_b32 s65, s21, 3
    s_lshl_b32 s44, s24, 1
    s_add_u32 s65, s65, s44
    s_lshl_b32 s44, s68, 1
    s_add_u32 s44, s44, s25
    s_lshl_b32 s44, s44, 6
    s_add_u32 s68, s44, s65
    s_lshl_b32 s44, s69, 1
    s_add_u32 s44, s44, s25
    s_lshl_b32 s44, s44, 6
    s_add_u32 s69, s44, s65
    s_lshl_b32 s44, s70, 1
    s_add_u32 s44, s44, s25
    s_lshl_b32 s44, s44, 6
    s_add_u32 s70, s44, s65
    v_lshlrev_b32 v11, 4, v1
    v_and_b32 v12, 15, v1
    v_lshrrev_b32 v13, 4, v1
    v_lshlrev_b32 v13, 9, v13
    v_lshl_add_u32 v2, v12, 4, v13
    v_and_b32 v12, 8, v1
    v_lshl_add_u32 v3, v12, 4, v2
    s_cmp_eq_u32 s20, 1
    s_cbranch_scc1 K1_EPI_B
    s_lshl_b32 s66, s68, 11
    s_add_u32 s66, s66, 0
    s_lshl_b32 s67, s69, 12
    s_add_u32 s67, s67, 4194304
    s_add_u32 s45, s67, 4096
    s_lshl_b32 s71, s70, 12
    s_add_u32 s71, s71, 4194304
    s_add_u32 s47, s71, 4096
    s_mov_b32 s46, 0x3e8293ee
    s_waitcnt lgkmcnt(0)
    v_mul_f32 v16, s46, v16
    v_mul_f32 v32, s46, v32
    v_mul_f32 v17, s46, v17
    v_mul_f32 v33, s46, v33
    v_mul_f32 v18, s46, v18
    v_mul_f32 v34, s46, v34
    v_mul_f32 v19, s46, v19
    v_mul_f32 v35, s46, v35
    v_cvt_pk_bf16_f32 v112, v16, v17
    v_cvt_pk_bf16_f32 v113, v18, v19
    v_cvt_pk_bf16_f32 v114, v32, v33
    v_cvt_pk_bf16_f32 v115, v34, v35
    buffer_store_dwordx4 v[112:115], v2, s[12:15], s66 offen offset:0 sc1
    v_mul_f32 v20, s46, v20
    v_mul_f32 v36, s46, v36
    v_mul_f32 v21, s46, v21
    v_mul_f32 v37, s46, v37
    v_mul_f32 v22, s46, v22
    v_mul_f32 v38, s46, v38
    v_mul_f32 v23, s46, v23
    v_mul_f32 v39, s46, v39
    v_cvt_pk_bf16_f32 v116, v20, v21
    v_cvt_pk_bf16_f32 v117, v22, v23
    v_cvt_pk_bf16_f32 v118, v36, v37
    v_cvt_pk_bf16_f32 v119, v38, v39
    buffer_store_dwordx4 v[116:119], v2, s[12:15], s66 offen offset:256 sc1
    v_mul_f32 v24, s46, v24
    v_mul_f32 v40, s46, v40
    v_mul_f32 v25, s46, v25
    v_mul_f32 v41, s46, v41
    v_mul_f32 v26, s46, v26
    v_mul_f32 v42, s46, v42
    v_mul_f32 v27, s46, v27
    v_mul_f32 v43, s46, v43
    v_cvt_pk_bf16_f32 v120, v24, v25
    v_cvt_pk_bf16_f32 v121, v26, v27
    v_cvt_pk_bf16_f32 v122, v40, v41
    v_cvt_pk_bf16_f32 v123, v42, v43
    buffer_store_dwordx4 v[120:123], v2, s[12:15], s66 offen offset:2048 sc1
    v_mul_f32 v28, s46, v28
    v_mul_f32 v44, s46, v44
    v_mul_f32 v29, s46, v29
    v_mul_f32 v45, s46, v45
    v_mul_f32 v30, s46, v30
    v_mul_f32 v46, s46, v46
    v_mul_f32 v31, s46, v31
    v_mul_f32 v47, s46, v47
    v_cvt_pk_bf16_f32 v124, v28, v29
    v_cvt_pk_bf16_f32 v125, v30, v31
    v_cvt_pk_bf16_f32 v126, v44, v45
    v_cvt_pk_bf16_f32 v127, v46, v47
    buffer_store_dwordx4 v[124:127], v2, s[12:15], s66 offen offset:2304 sc1
    v_cvt_pk_bf16_f32 v128, v48, v49
    v_cvt_pk_bf16_f32 v129, v50, v51
    v_cvt_pk_bf16_f32 v130, v64, v65
    v_cvt_pk_bf16_f32 v131, v66, v67
    buffer_store_dwordx4 v[128:131], v3, s[12:15], s67 offen offset:0 sc1
    v_cvt_pk_bf16_f32 v132, v52, v53
    v_cvt_pk_bf16_f32 v133, v54, v55
    v_cvt_pk_bf16_f32 v134, v68, v69
    v_cvt_pk_bf16_f32 v135, v70, v71
    buffer_store_dwordx4 v[132:135], v3, s[12:15], s67 offen offset:128 sc1
    v_cvt_pk_bf16_f32 v136, v56, v57
    v_cvt_pk_bf16_f32 v137, v58, v59
    v_cvt_pk_bf16_f32 v138, v72, v73
    v_cvt_pk_bf16_f32 v139, v74, v75
    buffer_store_dwordx4 v[136:139], v3, s[12:15], s45 offen offset:0 sc1
    v_cvt_pk_bf16_f32 v140, v60, v61
    v_cvt_pk_bf16_f32 v141, v62, v63
    v_cvt_pk_bf16_f32 v142, v76, v77
    v_cvt_pk_bf16_f32 v143, v78, v79
    buffer_store_dwordx4 v[140:143], v3, s[12:15], s45 offen offset:128 sc1
    v_cvt_pk_bf16_f32 v112, v80, v81
    v_cvt_pk_bf16_f32 v113, v82, v83
    v_cvt_pk_bf16_f32 v114, v84, v85
    v_cvt_pk_bf16_f32 v115, v86, v87
    buffer_store_dwordx4 v[112:115], v2, s[12:15], s71 offen offset:2048 sc1
    v_cvt_pk_bf16_f32 v116, v96, v97
    v_cvt_pk_bf16_f32 v117, v98, v99
    v_cvt_pk_bf16_f32 v118, v100, v101
    v_cvt_pk_bf16_f32 v119, v102, v103
    buffer_store_dwordx4 v[116:119], v2, s[12:15], s71 offen offset:2304 sc1
    v_cvt_pk_bf16_f32 v120, v88, v89
    v_cvt_pk_bf16_f32 v121, v90, v91
    v_cvt_pk_bf16_f32 v122, v92, v93
    v_cvt_pk_bf16_f32 v123, v94, v95
    buffer_store_dwordx4 v[120:123], v2, s[12:15], s47 offen offset:2048 sc1
    v_cvt_pk_bf16_f32 v124, v104, v105
    v_cvt_pk_bf16_f32 v125, v106, v107
    v_cvt_pk_bf16_f32 v126, v108, v109
    v_cvt_pk_bf16_f32 v127, v110, v111
    buffer_store_dwordx4 v[124:127], v2, s[12:15], s47 offen offset:2304 sc1
    s_branch K1_FIN
K1_EPI_B:
    s_lshl_b32 s66, s68, 11
    s_add_u32 s66, s66, 12582912
    s_mov_b32 s90, 0x3fb8aa3b
    s_mov_b32 s91, 0x3fb8aa3b
    s_lshl_b32 s45, s25, 11
    s_add_u32 s45, s45, 159744
    v_bfe_u32 v13, v1, 2, 2
    v_lshrrev_b32 v14, 5, v1
    v_lshl_add_u32 v13, v14, 3, v13
    v_lshlrev_b32 v12, 6, v13
    v_bfe_u32 v13, v1, 4, 1
    v_lshl_add_u32 v12, v13, 5, v12
    v_and_b32 v13, 3, v1
    v_lshl_add_u32 v12, v13, 3, v12
    v_add_u32 v12, s45, v12
    s_waitcnt lgkmcnt(0)
    ds_read_b64_tr_b16 v[160:161], v12 offset:0
    ds_read_b64_tr_b16 v[162:163], v12 offset:1024
    ds_read_b64_tr_b16 v[164:165], v12 offset:256
    ds_read_b64_tr_b16 v[166:167], v12 offset:1280
    v_cvt_pk_bf16_f32 v128, v48, v49
    v_cvt_pk_bf16_f32 v129, v50, v51
    v_cvt_pk_bf16_f32 v130, v64, v65
    v_cvt_pk_bf16_f32 v131, v66, v67
    v_cvt_pk_bf16_f32 v132, v52, v53
    v_cvt_pk_bf16_f32 v133, v54, v55
    v_cvt_pk_bf16_f32 v134, v68, v69
    v_cvt_pk_bf16_f32 v135, v70, v71
    v_cvt_pk_bf16_f32 v136, v56, v57
    v_cvt_pk_bf16_f32 v137, v58, v59
    v_cvt_pk_bf16_f32 v138, v72, v73
    v_cvt_pk_bf16_f32 v139, v74, v75
    v_cvt_pk_bf16_f32 v140, v60, v61
    v_cvt_pk_bf16_f32 v141, v62, v63
    v_cvt_pk_bf16_f32 v142, v76, v77
    v_cvt_pk_bf16_f32 v143, v78, v79
    s_nop 1
    v_permlane16_swap_b32 v128, v132
    v_permlane16_swap_b32 v129, v133
    v_permlane16_swap_b32 v130, v134
    v_permlane16_swap_b32 v131, v135
    v_permlane16_swap_b32 v136, v140
    v_permlane16_swap_b32 v137, v141
    v_permlane16_swap_b32 v138, v142
    v_permlane16_swap_b32 v139, v143
    s_waitcnt vmcnt(0) lgkmcnt(0)
    s_nop 0
    v_mfma_f32_32x32x16_bf16 v[48:63], v[160:163], v[128:131], 0
    v_mfma_f32_32x32x16_bf16 v[48:63], v[164:167], v[132:135], v[48:63]
    v_mfma_f32_32x32x16_bf16 v[64:79], v[160:163], v[136:139], 0
    v_mfma_f32_32x32x16_bf16 v[64:79], v[164:167], v[140:143], v[64:79]
    v_cvt_pk_bf16_f32 v112, v16, v17
    v_cvt_pk_bf16_f32 v113, v18, v19
    v_cvt_pk_bf16_f32 v114, v32, v33
    v_cvt_pk_bf16_f32 v115, v34, v35
    v_cvt_pk_bf16_f32 v116, v20, v21
    v_cvt_pk_bf16_f32 v117, v22, v23
    v_cvt_pk_bf16_f32 v118, v36, v37
    v_cvt_pk_bf16_f32 v119, v38, v39
    v_cvt_pk_bf16_f32 v120, v24, v25
    v_cvt_pk_bf16_f32 v121, v26, v27
    v_cvt_pk_bf16_f32 v122, v40, v41
    v_cvt_pk_bf16_f32 v123, v42, v43
    v_cvt_pk_bf16_f32 v124, v28, v29
    v_cvt_pk_bf16_f32 v125, v30, v31
    v_cvt_pk_bf16_f32 v126, v44, v45
    v_cvt_pk_bf16_f32 v127, v46, v47
    v_cvt_pk_bf16_f32 v144, v80, v81
    v_cvt_pk_bf16_f32 v145, v82, v83
    v_cvt_pk_bf16_f32 v146, v84, v85
    v_cvt_pk_bf16_f32 v147, v86, v87
    v_cvt_pk_bf16_f32 v148, v96, v97
    v_cvt_pk_bf16_f32 v149, v98, v99
    v_cvt_pk_bf16_f32 v150, v100, v101
    v_cvt_pk_bf16_f32 v151, v102, v103
    v_cvt_pk_bf16_f32 v152, v88, v89
    v_cvt_pk_bf16_f32 v153, v90, v91
    v_cvt_pk_bf16_f32 v154, v92, v93
    v_cvt_pk_bf16_f32 v155, v94, v95
    v_cvt_pk_bf16_f32 v156, v104, v105
    v_cvt_pk_bf16_f32 v157, v106, v107
    v_cvt_pk_bf16_f32 v158, v108, v109
    v_cvt_pk_bf16_f32 v159, v110, v111
    s_nop 1
    v_permlane16_swap_b32 v144, v148
    v_permlane16_swap_b32 v145, v149
    v_permlane16_swap_b32 v146, v150
    v_permlane16_swap_b32 v147, v151
    v_permlane16_swap_b32 v152, v156
    v_permlane16_swap_b32 v153, v157
    v_permlane16_swap_b32 v154, v158
    v_permlane16_swap_b32 v155, v159
    v_bfe_u32 v236, v1, 4, 1
    v_bfe_u32 v237, v1, 2, 1
    v_cmp_eq_u32 vcc, v236, v237
    v_mov_b32 v238, 0x3f803f80
    v_and_b32 v15, 31, v1
    v_lshrrev_b32 v13, 5, v1
    v_cndmask_b32 v168, 0, v238, vcc
    v_mov_b32 v169, v168
    v_mov_b32 v170, v168
    v_mov_b32 v171, v168
    v_lshlrev_b32 v13, 1, v13
    v_and_b32 v14, 7, v15
    v_xor_b32 v13, v13, v14
    v_lshlrev_b32 v13, 4, v13
    v_lshl_add_u32 v13, v15, 7, v13
    s_lshl_b32 s46, s23, 13
    s_add_u32 s46, s46, 65536
    v_add_u32 v13, s46, v13
    v_bfe_u32 v15, v1, 2, 2
    v_and_b32 v14, 1, v1
    v_lshlrev_b32 v14, 1, v14
    v_bfe_u32 v236, v1, 4, 1
    v_add_u32 v14, v14, v236
    v_xor_b32 v14, v14, v15
    v_lshlrev_b32 v14, 4, v14
    v_lshrrev_b32 v236, 5, v1
    v_lshl_add_u32 v15, v236, 3, v15
    v_lshl_add_u32 v14, v15, 7, v14
    v_bfe_u32 v236, v1, 1, 1
    v_lshl_add_u32 v14, v236, 3, v14
    v_add_u32 v14, s46, v14
    v_xor_b32 v15, 64, v14
    v_xor_b32 v244, 16, v13
    v_xor_b32 v245, 64, v13
    v_xor_b32 v246, 0x50, v13
    v_max3_f32 v236, v48, v49, v50
    v_min3_f32 v237, v48, v49, v50
    v_max3_f32 v236, v236, v51, v52
    v_min3_f32 v237, v237, v51, v52
    v_max3_f32 v236, v236, v53, v54
    v_min3_f32 v237, v237, v53, v54
    v_max3_f32 v236, v236, v55, v56
    v_min3_f32 v237, v237, v55, v56
    v_max3_f32 v236, v236, v57, v58
    v_min3_f32 v237, v237, v57, v58
    v_max3_f32 v236, v236, v59, v60
    v_min3_f32 v237, v237, v59, v60
    v_max3_f32 v236, v236, v61, v62
    v_min3_f32 v237, v237, v61, v62
    v_max_f32 v236, v236, v63
    v_min_f32 v237, v237, v63
    v_mov_b32 v238, v236
    v_mov_b32 v239, v237
    s_nop 1
    v_permlane32_swap_b32 v236, v238
    v_permlane32_swap_b32 v237, v239
    s_nop 1
    v_max_f32 v236, v236, v238
    v_min_f32 v237, v237, v239
    v_mul_f32 v240, s90, v236
    v_mul_f32 v241, s90, v237
    v_fma_f32 v204, v48, s90, -v240
    v_fma_f32 v220, -v48, s90, v241
    v_fma_f32 v205, v49, s90, -v240
    v_fma_f32 v221, -v49, s90, v241
    v_fma_f32 v206, v50, s90, -v240
    v_fma_f32 v222, -v50, s90, v241
    v_fma_f32 v207, v51, s90, -v240
    v_fma_f32 v223, -v51, s90, v241
    v_fma_f32 v208, v52, s90, -v240
    v_fma_f32 v224, -v52, s90, v241
    v_fma_f32 v209, v53, s90, -v240
    v_fma_f32 v225, -v53, s90, v241
    v_fma_f32 v210, v54, s90, -v240
    v_fma_f32 v226, -v54, s90, v241
    v_fma_f32 v211, v55, s90, -v240
    v_fma_f32 v227, -v55, s90, v241
    v_fma_f32 v212, v56, s90, -v240
    v_fma_f32 v228, -v56, s90, v241
    v_fma_f32 v213, v57, s90, -v240
    v_fma_f32 v229, -v57, s90, v241
    v_fma_f32 v214, v58, s90, -v240
    v_fma_f32 v230, -v58, s90, v241
    v_fma_f32 v215, v59, s90, -v240
    v_fma_f32 v231, -v59, s90, v241
    v_fma_f32 v216, v60, s90, -v240
    v_fma_f32 v232, -v60, s90, v241
    v_fma_f32 v217, v61, s90, -v240
    v_fma_f32 v233, -v61, s90, v241
    v_fma_f32 v218, v62, s90, -v240
    v_fma_f32 v234, -v62, s90, v241
    v_fma_f32 v219, v63, s90, -v240
    v_fma_f32 v235, -v63, s90, v241
    v_exp_f32 v204, v204
    v_exp_f32 v205, v205
    v_exp_f32 v206, v206
    v_exp_f32 v207, v207
    v_exp_f32 v208, v208
    v_exp_f32 v209, v209
    v_exp_f32 v210, v210
    v_exp_f32 v211, v211
    v_exp_f32 v212, v212
    v_exp_f32 v213, v213
    v_exp_f32 v214, v214
    v_exp_f32 v215, v215
    v_exp_f32 v216, v216
    v_exp_f32 v217, v217
    v_exp_f32 v218, v218
    v_exp_f32 v219, v219
    v_exp_f32 v220, v220
    v_exp_f32 v221, v221
    v_exp_f32 v222, v222
    v_exp_f32 v223, v223
    v_exp_f32 v224, v224
    v_exp_f32 v225, v225
    v_exp_f32 v226, v226
    v_exp_f32 v227, v227
    v_exp_f32 v228, v228
    v_exp_f32 v229, v229
    v_exp_f32 v230, v230
    v_exp_f32 v231, v231
    v_exp_f32 v232, v232
    v_exp_f32 v233, v233
    v_exp_f32 v234, v234
    v_exp_f32 v235, v235
    v_add_f32 v236, v204, v205
    v_add_f32 v237, v220, v221
    v_add_f32 v238, v206, v207
    v_add_f32 v239, v222, v223
    v_add_f32 v236, v236, v208
    v_add_f32 v237, v237, v224
    v_add_f32 v238, v238, v209
    v_add_f32 v239, v239, v225
    v_add_f32 v236, v236, v210
    v_add_f32 v237, v237, v226
    v_add_f32 v238, v238, v211
    v_add_f32 v239, v239, v227
    v_add_f32 v236, v236, v212
    v_add_f32 v237, v237, v228
    v_add_f32 v238, v238, v213
    v_add_f32 v239, v239, v229
    v_add_f32 v236, v236, v214
    v_add_f32 v237, v237, v230
    v_add_f32 v238, v238, v215
    v_add_f32 v239, v239, v231
    v_add_f32 v236, v236, v216
    v_add_f32 v237, v237, v232
    v_add_f32 v238, v238, v217
    v_add_f32 v239, v239, v233
    v_add_f32 v236, v236, v218
    v_add_f32 v237, v237, v234
    v_add_f32 v238, v238, v219
    v_add_f32 v239, v239, v235
    v_add_f32 v240, v236, v238
    v_add_f32 v241, v237, v239
    v_mov_b32 v242, v240
    v_mov_b32 v243, v241
    s_nop 1
    v_permlane32_swap_b32 v240, v242
    v_permlane32_swap_b32 v241, v243
    s_nop 1
    v_add_f32 v240, v240, v242
    v_add_f32 v241, v241, v243
    v_rcp_f32 v240, v240
    v_rcp_f32 v241, v241
    s_nop 0
    v_mul_f32 v204, v204, v240
    v_mul_f32 v220, v220, v241
    v_mul_f32 v205, v205, v240
    v_mul_f32 v221, v221, v241
    v_mul_f32 v206, v206, v240
    v_mul_f32 v222, v222, v241
    v_mul_f32 v207, v207, v240
    v_mul_f32 v223, v223, v241
    v_mul_f32 v208, v208, v240
    v_mul_f32 v224, v224, v241
    v_mul_f32 v209, v209, v240
    v_mul_f32 v225, v225, v241
    v_mul_f32 v210, v210, v240
    v_mul_f32 v226, v226, v241
    v_mul_f32 v211, v211, v240
    v_mul_f32 v227, v227, v241
    v_mul_f32 v212, v212, v240
    v_mul_f32 v228, v228, v241
    v_mul_f32 v213, v213, v240
    v_mul_f32 v229, v229, v241
    v_mul_f32 v214, v214, v240
    v_mul_f32 v230, v230, v241
    v_mul_f32 v215, v215, v240
    v_mul_f32 v231, v231, v241
    v_mul_f32 v216, v216, v240
    v_mul_f32 v232, v232, v241
    v_mul_f32 v217, v217, v240
    v_mul_f32 v233, v233, v241
    v_mul_f32 v218, v218, v240
    v_mul_f32 v234, v234, v241
    v_mul_f32 v219, v219, v240
    v_mul_f32 v235, v235, v241
    v_cvt_pk_bf16_f32 v172, v204, v205
    v_cvt_pk_bf16_f32 v173, v206, v207
    v_cvt_pk_bf16_f32 v174, v208, v209
    v_cvt_pk_bf16_f32 v175, v210, v211
    v_cvt_pk_bf16_f32 v176, v212, v213
    v_cvt_pk_bf16_f32 v177, v214, v215
    v_cvt_pk_bf16_f32 v178, v216, v217
    v_cvt_pk_bf16_f32 v179, v218, v219
    v_cvt_pk_bf16_f32 v180, v220, v221
    v_cvt_pk_bf16_f32 v181, v222, v223
    v_cvt_pk_bf16_f32 v182, v224, v225
    v_cvt_pk_bf16_f32 v183, v226, v227
    v_cvt_pk_bf16_f32 v184, v228, v229
    v_cvt_pk_bf16_f32 v185, v230, v231
    v_cvt_pk_bf16_f32 v186, v232, v233
    v_cvt_pk_bf16_f32 v187, v234, v235
    s_barrier
    ds_write_b128 v13, v[172:175] offset:0
    ds_write_b128 v244, v[176:179] offset:0
    ds_write_b128 v245, v[180:183] offset:0
    ds_write_b128 v246, v[184:187] offset:0
    ds_read_b64_tr_b16 v[188:189], v14 offset:0
    ds_read_b64_tr_b16 v[190:191], v14 offset:2048
    ds_read_b64_tr_b16 v[192:193], v15 offset:512
    ds_read_b64_tr_b16 v[194:195], v15 offset:2560
    ds_read_b64_tr_b16 v[196:197], v15 offset:0
    ds_read_b64_tr_b16 v[198:199], v15 offset:2048
    ds_read_b64_tr_b16 v[200:201], v14 offset:512
    ds_read_b64_tr_b16 v[202:203], v14 offset:2560
    v_max3_f32 v236, v64, v65, v66
    v_min3_f32 v237, v64, v65, v66
    v_max3_f32 v236, v236, v67, v68
    v_min3_f32 v237, v237, v67, v68
    v_max3_f32 v236, v236, v69, v70
    v_min3_f32 v237, v237, v69, v70
    v_max3_f32 v236, v236, v71, v72
    v_min3_f32 v237, v237, v71, v72
    v_max3_f32 v236, v236, v73, v74
    v_min3_f32 v237, v237, v73, v74
    v_max3_f32 v236, v236, v75, v76
    v_min3_f32 v237, v237, v75, v76
    v_max3_f32 v236, v236, v77, v78
    v_min3_f32 v237, v237, v77, v78
    v_max_f32 v236, v236, v79
    v_min_f32 v237, v237, v79
    v_mov_b32 v238, v236
    v_mov_b32 v239, v237
    s_nop 1
    v_permlane32_swap_b32 v236, v238
    v_permlane32_swap_b32 v237, v239
    s_nop 1
    v_max_f32 v236, v236, v238
    v_min_f32 v237, v237, v239
    v_mul_f32 v240, s90, v236
    v_mul_f32 v241, s90, v237
    v_fma_f32 v204, v64, s90, -v240
    v_fma_f32 v220, -v64, s90, v241
    v_fma_f32 v205, v65, s90, -v240
    v_fma_f32 v221, -v65, s90, v241
    v_fma_f32 v206, v66, s90, -v240
    v_fma_f32 v222, -v66, s90, v241
    v_fma_f32 v207, v67, s90, -v240
    v_fma_f32 v223, -v67, s90, v241
    v_fma_f32 v208, v68, s90, -v240
    v_fma_f32 v224, -v68, s90, v241
    v_fma_f32 v209, v69, s90, -v240
    v_fma_f32 v225, -v69, s90, v241
    v_fma_f32 v210, v70, s90, -v240
    v_fma_f32 v226, -v70, s90, v241
    v_fma_f32 v211, v71, s90, -v240
    v_fma_f32 v227, -v71, s90, v241
    v_fma_f32 v212, v72, s90, -v240
    v_fma_f32 v228, -v72, s90, v241
    v_fma_f32 v213, v73, s90, -v240
    v_fma_f32 v229, -v73, s90, v241
    v_fma_f32 v214, v74, s90, -v240
    v_fma_f32 v230, -v74, s90, v241
    v_fma_f32 v215, v75, s90, -v240
    v_fma_f32 v231, -v75, s90, v241
    v_fma_f32 v216, v76, s90, -v240
    v_fma_f32 v232, -v76, s90, v241
    v_fma_f32 v217, v77, s90, -v240
    v_fma_f32 v233, -v77, s90, v241
    v_fma_f32 v218, v78, s90, -v240
    v_fma_f32 v234, -v78, s90, v241
    s_waitcnt lgkmcnt(0)
    v_fma_f32 v219, v79, s90, -v240
    v_fma_f32 v235, -v79, s90, v241
    v_mfma_f32_32x32x16_bf16 v[16:31], v[188:191], v[144:147], 0
    v_exp_f32 v204, v204
    v_exp_f32 v205, v205
    v_exp_f32 v206, v206
    v_exp_f32 v207, v207
    v_exp_f32 v208, v208
    v_mfma_f32_16x16x32_bf16 v[80:83], v[168:171], v[188:191], 0
    v_exp_f32 v209, v209
    v_exp_f32 v210, v210
    v_exp_f32 v211, v211
    v_exp_f32 v212, v212
    v_exp_f32 v213, v213
    v_mfma_f32_32x32x16_bf16 v[16:31], v[192:195], v[148:151], v[16:31]
    v_exp_f32 v214, v214
    v_exp_f32 v215, v215
    v_exp_f32 v216, v216
    v_exp_f32 v217, v217
    v_exp_f32 v218, v218
    v_mfma_f32_16x16x32_bf16 v[80:83], v[168:171], v[192:195], v[80:83]
    v_exp_f32 v219, v219
    v_exp_f32 v220, v220
    v_exp_f32 v221, v221
    v_exp_f32 v222, v222
    v_exp_f32 v223, v223
    v_mfma_f32_32x32x16_bf16 v[32:47], v[196:199], v[144:147], 0
    v_exp_f32 v224, v224
    v_exp_f32 v225, v225
    v_exp_f32 v226, v226
    v_exp_f32 v227, v227
    v_exp_f32 v228, v228
    v_mfma_f32_16x16x32_bf16 v[84:87], v[168:171], v[196:199], 0
    v_exp_f32 v229, v229
    v_exp_f32 v230, v230
    v_exp_f32 v231, v231
    v_exp_f32 v232, v232
    v_exp_f32 v233, v233
    v_mfma_f32_32x32x16_bf16 v[32:47], v[200:203], v[148:151], v[32:47]
    v_exp_f32 v234, v234
    v_exp_f32 v235, v235
    v_add_f32 v236, v204, v205
    v_add_f32 v237, v220, v221
    v_add_f32 v238, v206, v207
    v_mfma_f32_16x16x32_bf16 v[84:87], v[168:171], v[200:203], v[84:87]
    v_add_f32 v239, v222, v223
    v_add_f32 v236, v236, v208
    v_add_f32 v237, v237, v224
    v_add_f32 v238, v238, v209
    v_add_f32 v239, v239, v225
    v_add_f32 v236, v236, v210
    v_add_f32 v237, v237, v226
    v_add_f32 v238, v238, v211
    v_add_f32 v239, v239, v227
    v_add_f32 v236, v236, v212
    v_add_f32 v237, v237, v228
    v_add_f32 v238, v238, v213
    v_add_f32 v239, v239, v229
    v_add_f32 v236, v236, v214
    v_add_f32 v237, v237, v230
    v_add_f32 v238, v238, v215
    v_add_f32 v239, v239, v231
    v_add_f32 v236, v236, v216
    v_add_f32 v237, v237, v232
    v_add_f32 v238, v238, v217
    v_add_f32 v239, v239, v233
    v_add_f32 v236, v236, v218
    v_add_f32 v237, v237, v234
    v_add_f32 v238, v238, v219
    v_add_f32 v239, v239, v235
    v_add_f32 v240, v236, v238
    v_add_f32 v241, v237, v239
    v_mov_b32 v242, v240
    v_mov_b32 v243, v241
    s_nop 1
    v_permlane32_swap_b32 v240, v242
    v_permlane32_swap_b32 v241, v243
    s_nop 1
    v_add_f32 v240, v240, v242
    v_add_f32 v241, v241, v243
    v_rcp_f32 v240, v240
    v_rcp_f32 v241, v241
    s_nop 0
    v_mul_f32 v204, v204, v240
    v_mul_f32 v220, v220, v241
    v_mul_f32 v205, v205, v240
    v_mul_f32 v221, v221, v241
    v_mul_f32 v206, v206, v240
    v_mul_f32 v222, v222, v241
    v_mul_f32 v207, v207, v240
    v_mul_f32 v223, v223, v241
    v_mul_f32 v208, v208, v240
    v_mul_f32 v224, v224, v241
    v_mul_f32 v209, v209, v240
    v_mul_f32 v225, v225, v241
    v_mul_f32 v210, v210, v240
    v_mul_f32 v226, v226, v241
    v_mul_f32 v211, v211, v240
    v_mul_f32 v227, v227, v241
    v_mul_f32 v212, v212, v240
    v_mul_f32 v228, v228, v241
    v_mul_f32 v213, v213, v240
    v_mul_f32 v229, v229, v241
    v_mul_f32 v214, v214, v240
    v_mul_f32 v230, v230, v241
    v_mul_f32 v215, v215, v240
    v_mul_f32 v231, v231, v241
    v_mul_f32 v216, v216, v240
    v_mul_f32 v232, v232, v241
    v_mul_f32 v217, v217, v240
    v_mul_f32 v233, v233, v241
    v_mul_f32 v218, v218, v240
    v_mul_f32 v234, v234, v241
    v_mul_f32 v219, v219, v240
    v_mul_f32 v235, v235, v241
    v_cvt_pk_bf16_f32 v172, v204, v205
    v_cvt_pk_bf16_f32 v173, v206, v207
    v_cvt_pk_bf16_f32 v174, v208, v209
    v_cvt_pk_bf16_f32 v175, v210, v211
    v_cvt_pk_bf16_f32 v176, v212, v213
    v_cvt_pk_bf16_f32 v177, v214, v215
    v_cvt_pk_bf16_f32 v178, v216, v217
    v_cvt_pk_bf16_f32 v179, v218, v219
    v_cvt_pk_bf16_f32 v180, v220, v221
    v_cvt_pk_bf16_f32 v181, v222, v223
    v_cvt_pk_bf16_f32 v182, v224, v225
    v_cvt_pk_bf16_f32 v183, v226, v227
    v_cvt_pk_bf16_f32 v184, v228, v229
    v_cvt_pk_bf16_f32 v185, v230, v231
    v_cvt_pk_bf16_f32 v186, v232, v233
    v_cvt_pk_bf16_f32 v187, v234, v235
    ds_write_b128 v13, v[172:175] offset:4096
    ds_write_b128 v244, v[176:179] offset:4096
    ds_write_b128 v245, v[180:183] offset:4096
    ds_write_b128 v246, v[184:187] offset:4096
    ds_read_b64_tr_b16 v[188:189], v14 offset:4096
    ds_read_b64_tr_b16 v[190:191], v14 offset:6144
    ds_read_b64_tr_b16 v[192:193], v15 offset:4608
    ds_read_b64_tr_b16 v[194:195], v15 offset:6656
    ds_read_b64_tr_b16 v[196:197], v15 offset:4096
    ds_read_b64_tr_b16 v[198:199], v15 offset:6144
    ds_read_b64_tr_b16 v[200:201], v14 offset:4608
    ds_read_b64_tr_b16 v[202:203], v14 offset:6656
    s_waitcnt lgkmcnt(0)
    v_mfma_f32_32x32x16_bf16 v[16:31], v[188:191], v[152:155], v[16:31]
    v_mfma_f32_16x16x32_bf16 v[80:83], v[168:171], v[188:191], v[80:83]
    v_mfma_f32_32x32x16_bf16 v[16:31], v[192:195], v[156:159], v[16:31]
    v_mfma_f32_16x16x32_bf16 v[80:83], v[168:171], v[192:195], v[80:83]
    v_mfma_f32_32x32x16_bf16 v[32:47], v[196:199], v[152:155], v[32:47]
    v_mfma_f32_16x16x32_bf16 v[84:87], v[168:171], v[196:199], v[84:87]
    v_mfma_f32_32x32x16_bf16 v[32:47], v[200:203], v[156:159], v[32:47]
    v_mfma_f32_16x16x32_bf16 v[84:87], v[168:171], v[200:203], v[84:87]
    buffer_store_dwordx4 v[112:115], v2, s[12:15], s66 offen offset:0 sc1
    buffer_store_dwordx4 v[116:119], v2, s[12:15], s66 offen offset:256 sc1
    buffer_store_dwordx4 v[120:123], v2, s[12:15], s66 offen offset:2048 sc1
    buffer_store_dwordx4 v[124:127], v2, s[12:15], s66 offen offset:2304 sc1
    s_lshl_b32 s46, s23, 13
    s_add_u32 s46, s46, 65536
    v_add_u32 v13, s46, v11
    v_lshlrev_b32 v14, 2, v1
    s_lshl_b32 s46, s23, 8
    s_add_u32 s46, s46, 147456
    v_add_u32 v15, s46, v14
    v_cmp_gt_u32 vcc, 32, v1
    s_nop 7
    ds_write_b128 v13, v[16:19] offset:0
    ds_write_b128 v13, v[20:23] offset:1024
    ds_write_b128 v13, v[24:27] offset:2048
    ds_write_b128 v13, v[28:31] offset:3072
    v_cndmask_b32 v236, v84, v80, vcc
    ds_write_b128 v13, v[32:35] offset:4096
    ds_write_b128 v13, v[36:39] offset:5120
    ds_write_b128 v13, v[40:43] offset:6144
    ds_write_b128 v13, v[44:47] offset:7168
    ds_write_b32 v15, v236
    s_lshl_b32 s46, s25, 15
    s_lshl_b32 s47, s24, 11
    s_add_u32 s46, s46, s47
    s_add_u32 s46, s46, 65536
    v_add_u32 v13, s46, v11
    s_lshl_b32 s46, s25, 10
    s_add_u32 s46, s46, 147456
    v_add_u32 v15, s46, v14
    s_lshl_b32 s46, s64, 3
    s_add_u32 s46, s46, s21
    s_lshl_b32 s45, s46, 13
    s_add_u32 s45, s45, s47
    s_add_u32 s45, s45, 16777216
    s_cmp_lg_u32 s23, 4
    s_cbranch_scc1 K1_E1
    s_mov_b32 s30, 0
TOKWE:
    v_readfirstlane_b32 s88, v250
    s_add_u32 s30, s30, 1
    s_nop 3
    s_cmp_lg_u32 s88, 0
    s_cbranch_scc1 TOKOKE
    buffer_load_dword v250, v251, s[96:99], 0 offen sc1
    s_waitcnt vmcnt(0)
    s_cmp_lt_u32 s30, 1000000
    s_cbranch_scc1 TOKWE
TOKOKE:
    s_mov_b32 s30, 0
    s_mov_b32 exec_hi, 0
POLL_AE:
    buffer_load_dword v196, v248, s[12:15], 0 offen sc1
    s_waitcnt vmcnt(0)
    v_cmp_ne_u32 vcc, s88, v196
    s_add_u32 s30, s30, 1
    s_nop 3
    s_cbranch_vccz POLL_AE_OK
    s_sleep 4
    s_cmp_lt_u32 s30, 1000000
    s_cbranch_scc1 POLL_AE
POLL_AE_OK:
    s_mov_b64 exec, -1
K1_E1:
    s_waitcnt lgkmcnt(0)
    s_barrier
    s_and_b32 s30, s2, 7
    s_lshl_b32 s30, s30, 2
    s_bfe_u32 s31, s2, 0x20003
    s_add_u32 s30, s30, s31
    s_lshl_b32 s31, s30, 18
    s_add_u32 s31, s31, 4194304
    s_lshl_b32 s32, s23, 12
    s_add_u32 s31, s31, s32
    s_mov_b32 m0, s32
    s_lshl_b32 s30, s30, 6
    buffer_load_dwordx4 v11, s[12:15], s31 offen offset:0 sc1 lds
    buffer_load_dwordx4 v11, s[12:15], s31 offen offset:1024 sc1 lds
    buffer_load_dwordx4 v11, s[12:15], s31 offen offset:2048 sc1 lds
    buffer_load_dwordx4 v11, s[12:15], s31 offen offset:3072 sc1 lds
    s_lshr_b32 s31, s2, 5
    s_lshl_b32 s31, s31, 3
    s_add_u32 s30, s30, s31
    s_add_u32 s30, s30, s23
    s_lshl_b32 s30, s30, 11
    buffer_load_dwordx4 v[188:191], v11, s[12:15], s30 offen sc1
    buffer_load_dwordx4 v[192:195], v11, s[12:15], s30 offen offset:1024 sc1
    ds_read_b128 v[204:207], v13 offset:0
    ds_read_b128 v[208:211], v13 offset:1024
    ds_read_b128 v[212:215], v13 offset:8192
    ds_read_b128 v[216:219], v13 offset:9216
    ds_read_b128 v[220:223], v13 offset:16384
    ds_read_b128 v[224:227], v13 offset:17408
    ds_read_b128 v[228:231], v13 offset:24576
    ds_read_b128 v[232:235], v13 offset:25600
    ds_read_b32 v236, v15 offset:0
    ds_read_b32 v237, v15 offset:256
    ds_read_b32 v238, v15 offset:512
    ds_read_b32 v239, v15 offset:768
    s_waitcnt lgkmcnt(8)
    v_add_f32 v204, v204, v212
    v_add_f32 v205, v205, v213
    v_add_f32 v206, v206, v214
    v_add_f32 v207, v207, v215
    v_add_f32 v208, v208, v216
    v_add_f32 v209, v209, v217
    v_add_f32 v210, v210, v218
    v_add_f32 v211, v211, v219
    s_waitcnt lgkmcnt(4)
    v_add_f32 v220, v220, v228
    v_add_f32 v221, v221, v229
    v_add_f32 v222, v222, v230
    v_add_f32 v223, v223, v231
    v_add_f32 v224, v224, v232
    v_add_f32 v225, v225, v233
    v_add_f32 v226, v226, v234
    v_add_f32 v227, v227, v235
    v_add_f32 v204, v204, v220
    v_add_f32 v205, v205, v221
    v_add_f32 v206, v206, v222
    v_add_f32 v207, v207, v223
    v_add_f32 v208, v208, v224
    v_add_f32 v209, v209, v225
    v_add_f32 v210, v210, v226
    v_add_f32 v211, v211, v227
    buffer_store_dwordx4 v[204:207], v11, s[12:15], s45 offen sc1
    buffer_store_dwordx4 v[208:211], v11, s[12:15], s45 offen offset:1024 sc1
    s_cmp_lg_u32 s24, 0
    s_cbranch_scc1 K1_END2
    s_waitcnt lgkmcnt(0)
    v_add_f32 v236, v236, v237
    v_add_f32 v236, v236, v238
    v_add_f32 v236, v236, v239
    s_lshl_b32 s46, s46, 8
    s_add_u32 s46, s46, 18874368
    buffer_store_dword v236, v14, s[12:15], s46 offen sc1
K1_END2:
K1_FIN:
    s_waitcnt vmcnt(0) lgkmcnt(0)
    s_barrier
    s_cmp_lg_u32 s23, 4
    s_cbranch_scc1 K1_PUB
    s_mov_b32 s45, 0
TOKWF:
    v_readfirstlane_b32 s88, v250
    s_add_u32 s45, s45, 1
    s_nop 3
    s_cmp_lg_u32 s88, 0
    s_cbranch_scc1 TOKOKF
    buffer_load_dword v250, v251, s[96:99], 0 offen sc1
    s_waitcnt vmcnt(0)
    s_cmp_lt_u32 s45, 1000000
    s_cbranch_scc1 TOKWF
TOKOKF:
    s_lshl_b32 s44, s20, 4
    s_add_u32 s44, s44, s22
    s_lshl_b32 s44, s44, 3
    s_add_u32 s44, s44, s21
    s_lshl_b32 s44, s44, 2
    s_add_u32 s44, s44, 19927040
    v_lshlrev_b32 v11, 10, v1
    v_mov_b32 v12, s88
    s_mov_b64 exec, 0xff
    buffer_store_dword v12, v11, s[12:15], s44 offen sc1
    s_mov_b64 exec, -1
K1_PUB:
    v_and_b32 v1, 63, v0
    v_lshrrev_b32 v5, 6, v0
    s_and_b32 s32, s2, 7
    s_lshr_b32 s33, s2, 3
    v_readfirstlane_b32 s22, v5
    s_lshl_b32 s20, s32, 2
    s_and_b32 s34, s33, 3
    s_add_u32 s20, s20, s34
    s_lshr_b32 s21, s33, 2
    v_lshlrev_b32 v2, 4, v1
    s_lshl_b32 s23, s21, 3
    s_add_u32 s23, s23, s22
    s_lshl_b32 s25, s22, 12
    s_mov_b32 s26, s25
    s_lshl_b32 s32, s20, 18
    s_add_u32 s32, s32, 4194304
    s_lshl_b32 s36, s20, 6
    s_add_u32 s36, s36, s23
    s_lshl_b32 s36, s36, 11
    s_add_u32 s34, s58, s32
    s_addc_u32 s35, s59, 0
    s_mov_b32 s4, s34
    s_mov_b32 s5, s35
    s_mov_b32 s6, 262144
    s_mov_b32 s7, 0x00020000
    s_mov_b32 s8, s58
    s_mov_b32 s9, s59
    s_mov_b32 s10, 29360128
    s_mov_b32 s11, 0x00020000
    s_and_b32 s29, s2, 7
    s_lshl_b32 s29, s29, 10
    s_add_u32 s29, s29, 19927040
    v_lshlrev_b32 v237, 3, v1
    s_bitcmp1_b32 s2, 7
    s_cbranch_scc0 K2_LATE
    s_add_u32 s25, s25, 32768
    s_add_u32 s26, s26, 32768
    v_mov_b32 v12, v188
    v_mov_b32 v13, v189
    v_mov_b32 v14, v190
    v_mov_b32 v15, v191
    v_mov_b32 v16, v192
    v_mov_b32 v17, v193
    v_mov_b32 v18, v194
    v_mov_b32 v19, v195
    s_branch K2_JOIN
K2_LATE:
    s_cmp_lg_u32 s22, 4
    s_cbranch_scc1 K2_W1
    s_mov_b32 s32, 0
    s_mov_b32 exec_hi, 0
POLL_A:
    buffer_load_dword v238, v248, s[8:11], 0 offen sc1
    s_waitcnt vmcnt(0)
    v_cmp_ne_u32 vcc, s88, v238
    s_add_u32 s32, s32, 1
    s_nop 3
    s_cbranch_vccz POLL_A_OK
    s_sleep 4
    s_cmp_lt_u32 s32, 1000000
    s_cbranch_scc1 POLL_A
POLL_A_OK:
    s_mov_b64 exec, -1
K2_W1:
    s_barrier
    s_mov_b32 m0, s26
    s_min_u32 s32, s25, 262144
    buffer_load_dwordx4 v2, s[4:7], s32 offen offset:0 sc1 lds
    buffer_load_dwordx4 v2, s[4:7], s32 offen offset:1024 sc1 lds
    buffer_load_dwordx4 v2, s[4:7], s32 offen offset:2048 sc1 lds
    buffer_load_dwordx4 v2, s[4:7], s32 offen offset:3072 sc1 lds
    s_add_u32 s25, s25, 32768
    s_add_u32 s26, s26, 32768
    s_and_b32 s26, s26, 131071
    buffer_load_dwordx4 v[12:15], v2, s[8:11], s36 offen sc1
    buffer_load_dwordx4 v[16:19], v2, s[8:11], s36 offen offset:1024 sc1
K2_JOIN:
    s_mov_b32 s12, s56
    s_mov_b32 s13, s57
    s_mov_b32 s14, 65536
    s_mov_b32 s15, 0x00020000
    s_add_u32 s37, s36, 12582912
    s_lshl_b32 s38, s20, 16
    s_lshl_b32 s34, s22, 10
    s_add_u32 s38, s38, s34
    s_add_u32 s38, s38, 16777216
    s_lshl_b32 s39, s20, 11
    s_lshl_b32 s34, s22, 8
    s_add_u32 s39, s39, s34
    s_add_u32 s39, s39, 18874368
    v_lshlrev_b32 v236, 2, v1
    s_mov_b32 s16, s62
    s_mov_b32 s17, s63
    s_mov_b32 s18, 2097152
    s_mov_b32 s19, 0x00020000
    s_mov_b32 s90, 0x3fb8aa3b
    s_mov_b32 s91, 0x3fb8aa3b
    s_lshl_b32 s36, s23, 5
    s_add_u32 s36, s36, s20
    s_lshl_b32 s36, s36, 11
    s_add_u32 s36, s36, 20971520
    v_bfe_u32 v5, v1, 4, 1
    v_bfe_u32 v6, v1, 2, 1
    v_cmp_eq_u32 vcc, v5, v6
    v_mov_b32 v7, 0x3f803f80
    s_nop 1
    v_cndmask_b32 v96, 0, v7, vcc
    v_mov_b32 v97, v96
    v_mov_b32 v98, v96
    v_mov_b32 v99, v96
    v_mov_b32 v76, 0
    v_mov_b32 v77, 0
    v_mov_b32 v78, 0
    v_mov_b32 v79, 0
    v_mov_b32 v80, 0
    v_mov_b32 v81, 0
    v_mov_b32 v82, 0
    v_mov_b32 v83, 0
    v_mov_b32 v84, 0
    v_mov_b32 v85, 0
    v_mov_b32 v86, 0
    v_mov_b32 v87, 0
    v_mov_b32 v88, 0
    v_mov_b32 v89, 0
    v_mov_b32 v90, 0
    v_mov_b32 v91, 0
    v_mov_b32 v92, 0
    v_mov_b32 v72, 0
    v_mov_b32 v112, 0
    v_mov_b32 v93, 0
    v_mov_b32 v73, 0
    v_mov_b32 v113, 0
    v_mov_b32 v94, 0
    v_mov_b32 v74, 0
    v_mov_b32 v114, 0
    v_mov_b32 v95, 0
    v_mov_b32 v75, 0
    v_mov_b32 v115, 0
    v_lshrrev_b32 v5, 3, v1
    v_and_b32 v6, 2, v5
    v_and_b32 v244, 7, v1
    v_xor_b32 v6, v6, v244
    v_lshlrev_b32 v6, 4, v6
    v_lshl_add_u32 v244, v5, 11, v6
    s_and_b32 s32, s22, 3
    s_lshl_b32 s48, s32, 15
    s_lshr_b32 s32, s22, 2
    s_lshl_b32 s32, s32, 7
    s_add_u32 s48, s48, s32
    s_and_b32 s32, s2, 1
    s_lshl_b32 s32, s32, 2
    s_lshr_b32 s33, s2, 6
    s_add_u32 s32, s32, s33
    s_lshl_b32 s32, s32, 8
    s_add_u32 s48, s48, s32
    s_lshl_b32 s49, s22, 11
    s_mov_b32 s27, 0
    s_mov_b32 s28, 32768
    v_mov_b32 v3, v2
    v_add_u32 v4, 32768, v2
    s_waitcnt vmcnt(0)
    s_barrier
    ds_read_b128 v[20:23], v3
    ds_read_b128 v[24:27], v3 offset:1024
    ds_read_b128 v[100:103], v3 offset:4096
    ds_read_b128 v[104:107], v3 offset:5120
    ds_read_b128 v[28:31], v3 offset:2048
    ds_read_b128 v[32:35], v3 offset:3072
    s_mov_b32 m0, s26
    s_min_u32 s32, s25, 262144
    buffer_load_dwordx4 v2, s[4:7], s32 offen offset:0 sc1 lds
    buffer_load_dwordx4 v2, s[4:7], s32 offen offset:1024 sc1 lds
    buffer_load_dwordx4 v2, s[4:7], s32 offen offset:2048 sc1 lds
    buffer_load_dwordx4 v2, s[4:7], s32 offen offset:3072 sc1 lds
    s_add_u32 s25, s25, 32768
    s_add_u32 s26, s26, 32768
    s_and_b32 s26, s26, 131071
    s_cmp_lg_u32 s22, 4
    s_cbranch_scc1 K2_W2
    s_mov_b32 s32, 0
    s_mov_b32 exec_hi, 0
POLL_A2:
    buffer_load_dword v238, v247, s[8:11], 0 offen sc1
    s_waitcnt vmcnt(0)
    v_cmp_ne_u32 vcc, s88, v238
    s_add_u32 s32, s32, 1
    s_nop 3
    s_cbranch_vccz POLL_A2_OK
    s_sleep 4
    s_cmp_lt_u32 s32, 1000000
    s_cbranch_scc1 POLL_A2
POLL_A2_OK:
    s_mov_b64 exec, -1
K2_W2:
    s_waitcnt lgkmcnt(4)
    v_mfma_f32_32x32x16_bf16 v[36:51], v[20:23], v[12:15], 0
    v_mfma_f32_32x32x16_bf16 v[36:51], v[24:27], v[16:19], v[36:51]
    s_mov_b32 s24, 0
    s_nop 11
    .p2align 6
K2_LOOP:
    s_waitcnt lgkmcnt(0)
    v_mfma_f32_32x32x16_bf16 v[52:67], v[100:103], v[12:15], 0
    ds_read_b128 v[20:23], v3 offset:8192
    v_exp_f32 v36, v36
    v_exp_f32 v37, v37
    v_exp_f32 v38, v38
    v_exp_f32 v39, v39
    v_mfma_f32_32x32x16_bf16 v[76:91], v[112:115], v[72:75], v[76:91]
    ds_read_b128 v[24:27], v3 offset:9216
    v_cvt_pk_bf16_f32 v68, v36, v37
    v_exp_f32 v40, v40
    v_cvt_pk_bf16_f32 v69, v38, v39
    v_exp_f32 v41, v41
    v_mfma_f32_32x32x16_bf16 v[52:67], v[104:107], v[16:19], v[52:67]
    ds_read_b128 v[108:111], v3 offset:6144
    v_exp_f32 v42, v42
    v_exp_f32 v43, v43
    v_cvt_pk_bf16_f32 v70, v40, v41
    v_exp_f32 v44, v44
    v_mfma_f32_16x16x32_bf16 v[92:95], v[96:99], v[72:75], v[92:95]
    ds_read_b128 v[112:115], v3 offset:7168
    v_cvt_pk_bf16_f32 v71, v42, v43
    v_exp_f32 v45, v45
    v_exp_f32 v46, v46
    v_exp_f32 v47, v47
    v_mfma_f32_32x32x16_bf16 v[76:91], v[28:31], v[68:71], v[76:91]
    v_cvt_pk_bf16_f32 v72, v44, v45
    v_exp_f32 v48, v48
    v_cvt_pk_bf16_f32 v73, v46, v47
    v_exp_f32 v49, v49
    v_mfma_f32_16x16x32_bf16 v[92:95], v[96:99], v[68:71], v[92:95]
    v_exp_f32 v50, v50
    v_exp_f32 v51, v51
    v_cvt_pk_bf16_f32 v74, v48, v49
    v_cvt_pk_bf16_f32 v75, v50, v51
    s_waitcnt lgkmcnt(0)
    v_mfma_f32_32x32x16_bf16 v[36:51], v[20:23], v[12:15], 0
    ds_read_b128 v[100:103], v3 offset:12288
    v_exp_f32 v52, v52
    v_exp_f32 v53, v53
    v_exp_f32 v54, v54
    v_exp_f32 v55, v55
    v_mfma_f32_32x32x16_bf16 v[76:91], v[32:35], v[72:75], v[76:91]
    ds_read_b128 v[104:107], v3 offset:13312
    v_cvt_pk_bf16_f32 v68, v52, v53
    v_exp_f32 v56, v56
    v_cvt_pk_bf16_f32 v69, v54, v55
    v_exp_f32 v57, v57
    v_mfma_f32_32x32x16_bf16 v[36:51], v[24:27], v[16:19], v[36:51]
    ds_read_b128 v[28:31], v3 offset:10240
    v_exp_f32 v58, v58
    v_exp_f32 v59, v59
    v_cvt_pk_bf16_f32 v70, v56, v57
    v_exp_f32 v60, v60
    v_mfma_f32_16x16x32_bf16 v[92:95], v[96:99], v[72:75], v[92:95]
    ds_read_b128 v[32:35], v3 offset:11264
    v_cvt_pk_bf16_f32 v71, v58, v59
    v_exp_f32 v61, v61
    v_exp_f32 v62, v62
    v_exp_f32 v63, v63
    v_mfma_f32_32x32x16_bf16 v[76:91], v[108:111], v[68:71], v[76:91]
    v_cvt_pk_bf16_f32 v72, v60, v61
    v_exp_f32 v64, v64
    v_cvt_pk_bf16_f32 v73, v62, v63
    v_exp_f32 v65, v65
    v_mfma_f32_16x16x32_bf16 v[92:95], v[96:99], v[68:71], v[92:95]
    v_exp_f32 v66, v66
    v_exp_f32 v67, v67
    v_cvt_pk_bf16_f32 v74, v64, v65
    v_cvt_pk_bf16_f32 v75, v66, v67
    s_waitcnt lgkmcnt(0)
    v_mfma_f32_32x32x16_bf16 v[52:67], v[100:103], v[12:15], 0
    ds_read_b128 v[20:23], v3 offset:16384
    v_exp_f32 v36, v36
    v_exp_f32 v37, v37
    v_exp_f32 v38, v38
    v_exp_f32 v39, v39
    v_mfma_f32_32x32x16_bf16 v[76:91], v[112:115], v[72:75], v[76:91]
    ds_read_b128 v[24:27], v3 offset:17408
    v_cvt_pk_bf16_f32 v68, v36, v37
    v_exp_f32 v40, v40
    v_cvt_pk_bf16_f32 v69, v38, v39
    v_exp_f32 v41, v41
    v_mfma_f32_32x32x16_bf16 v[52:67], v[104:107], v[16:19], v[52:67]
    ds_read_b128 v[108:111], v3 offset:14336
    v_exp_f32 v42, v42
    v_exp_f32 v43, v43
    v_cvt_pk_bf16_f32 v70, v40, v41
    v_exp_f32 v44, v44
    v_mfma_f32_16x16x32_bf16 v[92:95], v[96:99], v[72:75], v[92:95]
    ds_read_b128 v[112:115], v3 offset:15360
    v_cvt_pk_bf16_f32 v71, v42, v43
    v_exp_f32 v45, v45
    v_exp_f32 v46, v46
    v_exp_f32 v47, v47
    v_mfma_f32_32x32x16_bf16 v[76:91], v[28:31], v[68:71], v[76:91]
    v_cvt_pk_bf16_f32 v72, v44, v45
    v_exp_f32 v48, v48
    v_cvt_pk_bf16_f32 v73, v46, v47
    v_exp_f32 v49, v49
    v_mfma_f32_16x16x32_bf16 v[92:95], v[96:99], v[68:71], v[92:95]
    v_exp_f32 v50, v50
    v_exp_f32 v51, v51
    v_cvt_pk_bf16_f32 v74, v48, v49
    v_cvt_pk_bf16_f32 v75, v50, v51
    s_waitcnt lgkmcnt(0)
    v_mfma_f32_32x32x16_bf16 v[36:51], v[20:23], v[12:15], 0
    ds_read_b128 v[100:103], v3 offset:20480
    v_exp_f32 v52, v52
    v_exp_f32 v53, v53
    v_exp_f32 v54, v54
    v_exp_f32 v55, v55
    v_mfma_f32_32x32x16_bf16 v[76:91], v[32:35], v[72:75], v[76:91]
    ds_read_b128 v[104:107], v3 offset:21504
    v_cvt_pk_bf16_f32 v68, v52, v53
    v_exp_f32 v56, v56
    v_cvt_pk_bf16_f32 v69, v54, v55
    v_exp_f32 v57, v57
    v_mfma_f32_32x32x16_bf16 v[36:51], v[24:27], v[16:19], v[36:51]
    ds_read_b128 v[28:31], v3 offset:18432
    v_exp_f32 v58, v58
    v_exp_f32 v59, v59
    v_cvt_pk_bf16_f32 v70, v56, v57
    v_exp_f32 v60, v60
    v_mfma_f32_16x16x32_bf16 v[92:95], v[96:99], v[72:75], v[92:95]
    ds_read_b128 v[32:35], v3 offset:19456
    v_cvt_pk_bf16_f32 v71, v58, v59
    v_exp_f32 v61, v61
    v_exp_f32 v62, v62
    v_exp_f32 v63, v63
    v_mfma_f32_32x32x16_bf16 v[76:91], v[108:111], v[68:71], v[76:91]
    v_cvt_pk_bf16_f32 v72, v60, v61
    v_exp_f32 v64, v64
    v_cvt_pk_bf16_f32 v73, v62, v63
    v_exp_f32 v65, v65
    v_mfma_f32_16x16x32_bf16 v[92:95], v[96:99], v[68:71], v[92:95]
    v_exp_f32 v66, v66
    v_exp_f32 v67, v67
    v_cvt_pk_bf16_f32 v74, v64, v65
    v_cvt_pk_bf16_f32 v75, v66, v67
    s_waitcnt lgkmcnt(0)
    v_mfma_f32_32x32x16_bf16 v[52:67], v[100:103], v[12:15], 0
    ds_read_b128 v[20:23], v3 offset:24576
    v_exp_f32 v36, v36
    v_exp_f32 v37, v37
    v_exp_f32 v38, v38
    v_exp_f32 v39, v39
    v_mfma_f32_32x32x16_bf16 v[76:91], v[112:115], v[72:75], v[76:91]
    ds_read_b128 v[24:27], v3 offset:25600
    v_cvt_pk_bf16_f32 v68, v36, v37
    v_exp_f32 v40, v40
    v_cvt_pk_bf16_f32 v69, v38, v39
    v_exp_f32 v41, v41
    v_mfma_f32_32x32x16_bf16 v[52:67], v[104:107], v[16:19], v[52:67]
    ds_read_b128 v[108:111], v3 offset:22528
    v_exp_f32 v42, v42
    v_exp_f32 v43, v43
    v_cvt_pk_bf16_f32 v70, v40, v41
    v_exp_f32 v44, v44
    v_mfma_f32_16x16x32_bf16 v[92:95], v[96:99], v[72:75], v[92:95]
    ds_read_b128 v[112:115], v3 offset:23552
    v_cvt_pk_bf16_f32 v71, v42, v43
    v_exp_f32 v45, v45
    v_exp_f32 v46, v46
    v_exp_f32 v47, v47
    v_mfma_f32_32x32x16_bf16 v[76:91], v[28:31], v[68:71], v[76:91]
    v_cvt_pk_bf16_f32 v72, v44, v45
    v_exp_f32 v48, v48
    v_cvt_pk_bf16_f32 v73, v46, v47
    v_exp_f32 v49, v49
    v_mfma_f32_16x16x32_bf16 v[92:95], v[96:99], v[68:71], v[92:95]
    v_exp_f32 v50, v50
    v_exp_f32 v51, v51
    v_cvt_pk_bf16_f32 v74, v48, v49
    v_cvt_pk_bf16_f32 v75, v50, v51
    s_waitcnt lgkmcnt(0)
    v_mfma_f32_32x32x16_bf16 v[36:51], v[20:23], v[12:15], 0
    ds_read_b128 v[100:103], v3 offset:28672
    v_exp_f32 v52, v52
    v_exp_f32 v53, v53
    v_exp_f32 v54, v54
    v_exp_f32 v55, v55
    v_mfma_f32_32x32x16_bf16 v[76:91], v[32:35], v[72:75], v[76:91]
    ds_read_b128 v[104:107], v3 offset:29696
    v_cvt_pk_bf16_f32 v68, v52, v53
    v_exp_f32 v56, v56
    v_cvt_pk_bf16_f32 v69, v54, v55
    v_exp_f32 v57, v57
    v_mfma_f32_32x32x16_bf16 v[36:51], v[24:27], v[16:19], v[36:51]
    ds_read_b128 v[28:31], v3 offset:26624
    v_exp_f32 v58, v58
    v_exp_f32 v59, v59
    v_cvt_pk_bf16_f32 v70, v56, v57
    v_exp_f32 v60, v60
    v_mfma_f32_16x16x32_bf16 v[92:95], v[96:99], v[72:75], v[92:95]
    ds_read_b128 v[32:35], v3 offset:27648
    v_cvt_pk_bf16_f32 v71, v58, v59
    v_exp_f32 v61, v61
    v_exp_f32 v62, v62
    v_exp_f32 v63, v63
    v_mfma_f32_32x32x16_bf16 v[76:91], v[108:111], v[68:71], v[76:91]
    v_cvt_pk_bf16_f32 v72, v60, v61
    v_exp_f32 v64, v64
    v_cvt_pk_bf16_f32 v73, v62, v63
    v_exp_f32 v65, v65
    v_mfma_f32_16x16x32_bf16 v[92:95], v[96:99], v[68:71], v[92:95]
    v_exp_f32 v66, v66
    v_exp_f32 v67, v67
    v_cvt_pk_bf16_f32 v74, v64, v65
    v_cvt_pk_bf16_f32 v75, v66, v67
    s_waitcnt vmcnt(0) lgkmcnt(0)
    s_barrier
    v_mfma_f32_32x32x16_bf16 v[52:67], v[100:103], v[12:15], 0
    ds_read_b128 v[20:23], v4 offset:0
    v_exp_f32 v36, v36
    v_exp_f32 v37, v37
    v_exp_f32 v38, v38
    v_exp_f32 v39, v39
    v_mfma_f32_32x32x16_bf16 v[76:91], v[112:115], v[72:75], v[76:91]
    ds_read_b128 v[24:27], v4 offset:1024
    v_cvt_pk_bf16_f32 v68, v36, v37
    v_exp_f32 v40, v40
    v_cvt_pk_bf16_f32 v69, v38, v39
    v_exp_f32 v41, v41
    v_mfma_f32_32x32x16_bf16 v[52:67], v[104:107], v[16:19], v[52:67]
    ds_read_b128 v[108:111], v3 offset:30720
    v_exp_f32 v42, v42
    v_exp_f32 v43, v43
    v_cvt_pk_bf16_f32 v70, v40, v41
    v_exp_f32 v44, v44
    v_mfma_f32_16x16x32_bf16 v[92:95], v[96:99], v[72:75], v[92:95]
    ds_read_b128 v[112:115], v3 offset:31744
    v_cvt_pk_bf16_f32 v71, v42, v43
    v_exp_f32 v45, v45
    v_exp_f32 v46, v46
    v_exp_f32 v47, v47
    v_mfma_f32_32x32x16_bf16 v[76:91], v[28:31], v[68:71], v[76:91]
    v_cvt_pk_bf16_f32 v72, v44, v45
    v_exp_f32 v48, v48
    v_cvt_pk_bf16_f32 v73, v46, v47
    v_exp_f32 v49, v49
    v_mfma_f32_16x16x32_bf16 v[92:95], v[96:99], v[68:71], v[92:95]
    s_cmp_ge_u32 s24, 6
    s_cbranch_scc1 K2_NODMA
    s_mov_b32 m0, s26
    s_min_u32 s32, s25, 262144
    buffer_load_dwordx4 v2, s[4:7], s32 offen offset:0 sc1 lds
    buffer_load_dwordx4 v2, s[4:7], s32 offen offset:1024 sc1 lds
    buffer_load_dwordx4 v2, s[4:7], s32 offen offset:2048 sc1 lds
    buffer_load_dwordx4 v2, s[4:7], s32 offen offset:3072 sc1 lds
    s_add_u32 s25, s25, 32768
    s_add_u32 s26, s26, 32768
    s_and_b32 s26, s26, 131071
K2_NODMA:
    v_exp_f32 v50, v50
    v_exp_f32 v51, v51
    v_cvt_pk_bf16_f32 v74, v48, v49
    v_cvt_pk_bf16_f32 v75, v50, v51
    s_waitcnt lgkmcnt(0)
    v_mfma_f32_32x32x16_bf16 v[36:51], v[20:23], v[12:15], 0
    ds_read_b128 v[100:103], v4 offset:4096
    v_exp_f32 v52, v52
    v_exp_f32 v53, v53
    v_exp_f32 v54, v54
    v_exp_f32 v55, v55
    v_mfma_f32_32x32x16_bf16 v[76:91], v[32:35], v[72:75], v[76:91]
    ds_read_b128 v[104:107], v4 offset:5120
    v_cvt_pk_bf16_f32 v68, v52, v53
    v_exp_f32 v56, v56
    v_cvt_pk_bf16_f32 v69, v54, v55
    v_exp_f32 v57, v57
    v_mfma_f32_32x32x16_bf16 v[36:51], v[24:27], v[16:19], v[36:51]
    ds_read_b128 v[28:31], v4 offset:2048
    v_exp_f32 v58, v58
    v_exp_f32 v59, v59
    v_cvt_pk_bf16_f32 v70, v56, v57
    v_exp_f32 v60, v60
    v_mfma_f32_16x16x32_bf16 v[92:95], v[96:99], v[72:75], v[92:95]
    ds_read_b128 v[32:35], v4 offset:3072
    v_cvt_pk_bf16_f32 v71, v58, v59
    v_exp_f32 v61, v61
    v_exp_f32 v62, v62
    v_exp_f32 v63, v63
    v_mfma_f32_32x32x16_bf16 v[76:91], v[108:111], v[68:71], v[76:91]
    v_cvt_pk_bf16_f32 v72, v60, v61
    v_exp_f32 v64, v64
    v_cvt_pk_bf16_f32 v73, v62, v63
    v_exp_f32 v65, v65
    v_mfma_f32_16x16x32_bf16 v[92:95], v[96:99], v[68:71], v[92:95]
    v_exp_f32 v66, v66
    v_exp_f32 v67, v67
    v_cvt_pk_bf16_f32 v74, v64, v65
    s_mov_b32 s27, s28
    s_add_u32 s28, s28, 32768
    s_and_b32 s28, s28, 131071
    s_add_u32 s24, s24, 1
    v_cvt_pk_bf16_f32 v75, v66, v67
    v_mov_b32 v3, v4
    v_add_u32 v4, s28, v2
    s_cmp_lt_u32 s24, 8
    s_cbranch_scc1 K2_SIDE
    s_branch K2_DONE
K2_SIDE:
    s_cmp_lg_u32 s24, 7
    s_cbranch_scc1 K2_SIDEW
    s_add_u32 m0, s49, 32768
    s_add_u32 s32, s48, 524288
    buffer_load_dwordx4 v244, s[16:19], s32 offen lds
    s_add_u32 m0, s49, 33792
    s_add_u32 s32, s48, 540672
    buffer_load_dwordx4 v244, s[16:19], s32 offen lds
    s_add_u32 m0, s49, 49152
    s_add_u32 s32, s48, 655360
    buffer_load_dwordx4 v244, s[16:19], s32 offen lds
    s_add_u32 m0, s49, 50176
    s_add_u32 s32, s48, 671744
    buffer_load_dwordx4 v244, s[16:19], s32 offen lds
    s_branch K2_LOOP
K2_SIDEW:
    s_cmp_lg_u32 s24, 6
    s_cbranch_scc1 K2_SIDEX
    s_cmp_lg_u32 s22, 4
    s_cbranch_scc1 K2_PUBB
    s_lshl_b32 s32, s21, 6
    s_add_u32 s32, s32, s20
    s_lshl_b32 s32, s32, 2
    s_add_u32 s32, s32, 19923968
    v_mov_b32 v238, 0
    v_mov_b32 v239, s88
    s_mov_b64 exec, 1
    v_mov_b32 v238, 128
    s_mov_b64 exec, 4
    v_mov_b32 v238, 1024
    s_bitcmp1_b32 s2, 7
    s_cselect_b32 exec_lo, 1, 7
    buffer_store_dword v239, v238, s[8:11], s32 offen sc1
    s_mov_b64 exec, -1
K2_PUBB:
    s_add_u32 m0, s49, 0
    s_add_u32 s32, s48, 0
    buffer_load_dwordx4 v244, s[16:19], s32 offen lds
    s_add_u32 m0, s49, 1024
    s_add_u32 s32, s48, 16384
    buffer_load_dwordx4 v244, s[16:19], s32 offen lds
    s_add_u32 m0, s49, 16384
    s_add_u32 s32, s48, 131072
    buffer_load_dwordx4 v244, s[16:19], s32 offen lds
    s_add_u32 m0, s49, 17408
    s_add_u32 s32, s48, 147456
    buffer_load_dwordx4 v244, s[16:19], s32 offen lds
    s_add_u32 m0, s49, 131072
    s_add_u32 s32, s48, 262144
    buffer_load_dwordx4 v244, s[16:19], s32 offen lds
    s_add_u32 m0, s49, 132096
    s_add_u32 s32, s48, 278528
    buffer_load_dwordx4 v244, s[16:19], s32 offen lds
    s_add_u32 m0, s49, 147456
    s_add_u32 s32, s48, 393216
    buffer_load_dwordx4 v244, s[16:19], s32 offen lds
    s_add_u32 m0, s49, 148480
    s_add_u32 s32, s48, 409600
    buffer_load_dwordx4 v244, s[16:19], s32 offen lds
    s_branch K2_LOOP
K2_SIDEX:
    s_cmp_lg_u32 s24, 1
    s_cbranch_scc1 K2_SIDEY
    s_cmp_lg_u32 s22, 4
    s_cbranch_scc1 K2_LOOP
    s_add_u32 s33, s29, 512
    s_mov_b32 s32, 0
POLL_B:
    buffer_load_dwordx2 v[238:239], v237, s[8:11], s33 offen sc1
    s_waitcnt vmcnt(0)
    v_xor_b32 v238, s88, v238
    v_xor_b32 v239, s88, v239
    v_or_b32 v238, v238, v239
    v_cmp_ne_u32 vcc, 0, v238
    s_add_u32 s32, s32, 1
    s_nop 3
    s_cbranch_vccz POLL_B_OK
    s_sleep 4
    s_cmp_lt_u32 s32, 1000000
    s_cbranch_scc1 POLL_B
POLL_B_OK:
    s_mov_b64 exec, -1
    s_branch K2_LOOP
K2_SIDEY:
    s_cmp_eq_u32 s24, 5
    s_cbranch_scc1 K2_SIDE2
    s_cmp_eq_u32 s24, 4
    s_cbranch_scc1 K2_SIDE1
    s_cmp_eq_u32 s24, 3
    s_cbranch_scc1 K2_SIDE0B
    buffer_load_dwordx4 v[124:127], v2, s[8:11], s38 offen sc1
    s_add_u32 s38, s38, 8192
    buffer_load_dwordx4 v[116:119], v2, s[8:11], s37 offen sc1
    buffer_load_dwordx4 v[128:131], v2, s[8:11], s38 offen sc1
    s_add_u32 s38, s38, 8192
    buffer_load_dwordx4 v[120:123], v2, s[8:11], s37 offen offset:1024 sc1
    buffer_load_dwordx4 v[132:135], v2, s[8:11], s38 offen sc1
    s_add_u32 s38, s38, 8192
    buffer_load_dword v156, v236, s[8:11], s39 offen sc1
    s_branch K2_LOOP
K2_SIDE0B:
    buffer_load_dwordx4 v[136:139], v2, s[8:11], s38 offen sc1
    s_add_u32 s38, s38, 8192
    s_lshl_b32 s33, s20, 11
    s_lshl_b32 s34, s22, 8
    s_add_u32 s33, s33, s34
    s_add_u32 m0, s34, 137216
    s_nop 0
    buffer_load_dword v236, s[12:15], s33 offen lds
    buffer_load_dwordx4 v[140:143], v2, s[8:11], s38 offen sc1
    s_add_u32 s38, s38, 8192
    buffer_load_dwordx4 v[144:147], v2, s[8:11], s38 offen sc1
    s_add_u32 s38, s38, 8192
    buffer_load_dwordx4 v[148:151], v2, s[8:11], s38 offen sc1
    s_add_u32 s38, s38, 8192
    buffer_load_dwordx4 v[152:155], v2, s[8:11], s38 offen sc1
    s_add_u32 s38, s38, 8192
    s_branch K2_LOOP
K2_SIDE1:
    v_add_f32 v124, v124, v128
    v_add_f32 v125, v125, v129
    v_add_f32 v126, v126, v130
    v_add_f32 v127, v127, v131
    v_add_f32 v124, v124, v132
    v_add_f32 v125, v125, v133
    v_add_f32 v126, v126, v134
    v_add_f32 v127, v127, v135
    v_add_f32 v124, v124, v136
    v_add_f32 v125, v125, v137
    v_add_f32 v126, v126, v138
    v_add_f32 v127, v127, v139
    v_add_f32 v124, v124, v140
    v_add_f32 v125, v125, v141
    v_add_f32 v126, v126, v142
    v_add_f32 v127, v127, v143
    v_add_f32 v124, v124, v144
    v_add_f32 v125, v125, v145
    v_add_f32 v126, v126, v146
    v_add_f32 v127, v127, v147
    v_add_f32 v124, v124, v148
    v_add_f32 v125, v125, v149
    v_add_f32 v126, v126, v150
    v_add_f32 v127, v127, v151
    v_add_f32 v124, v124, v152
    v_add_f32 v125, v125, v153
    v_add_f32 v126, v126, v154
    v_add_f32 v127, v127, v155
    v_cvt_pk_bf16_f32 v128, v124, v125
    v_cvt_pk_bf16_f32 v129, v126, v127
    s_lshr_b32 s32, s22, 1
    s_lshl_b32 s32, s32, 10
    s_and_b32 s33, s22, 1
    s_lshl_b32 s33, s33, 3
    s_add_u32 s32, s32, s33
    s_add_u32 s32, s32, 131072
    v_add_u32 v237, s32, v2
    ds_write_b64 v237, v[128:129]
    s_lshl_b32 s32, s22, 8
    s_add_u32 s32, s32, 135168
    v_add_u32 v237, s32, v236
    ds_write_b32 v237, v156
    v_lshrrev_b32 v238, 3, v1
    v_and_b32 v238, 3, v238
    s_lshr_b32 s32, s2, 3
    s_lshl_b32 s32, s32, 5
    s_lshl_b32 s33, s22, 2
    s_add_u32 s32, s32, s33
    v_add_u32 v238, s32, v238
    v_lshlrev_b32 v238, 11, v238
    v_and_b32 v239, 7, v1
    v_lshl_add_u32 v238, v239, 7, v238
    s_and_b32 s32, s2, 1
    s_lshl_b32 s32, s32, 10
    s_mov_b32 exec_hi, 0
    buffer_load_dword v240, v238, s[16:19], s32 offen
    s_mov_b64 exec, -1
    s_waitcnt lgkmcnt(0)
    s_branch K2_LOOP
K2_SIDE2:
    s_add_u32 s51, s36, 4194304
    s_mov_b32 s50, 0
    s_cmp_ge_u32 s22, 4
    s_cbranch_scc1 K2_S2GO
    s_bitcmp1_b32 s2, 7
    s_cbranch_scc1 K2_LOOP
    s_mov_b32 s50, 1
K2_S2GO:
    v_add_u32 v237, 135168, v236
    ds_read_b32 v180, v237 offset:0
    ds_read_b32 v181, v237 offset:256
    ds_read_b32 v182, v237 offset:512
    ds_read_b32 v183, v237 offset:768
    ds_read_b32 v184, v237 offset:1024
    ds_read_b32 v185, v237 offset:1280
    ds_read_b32 v186, v237 offset:1536
    ds_read_b32 v187, v237 offset:1792
    v_bfe_u32 v238, v1, 2, 2
    v_lshrrev_b32 v239, 5, v1
    v_lshl_add_u32 v238, v239, 2, v238
    v_lshlrev_b32 v237, 6, v238
    v_bfe_u32 v238, v1, 4, 1
    v_lshl_add_u32 v237, v238, 5, v237
    v_and_b32 v238, 3, v1
    v_lshl_add_u32 v237, v238, 3, v237
    v_add_u32 v237, 137216, v237
    s_lshl_b32 s32, s22, 7
    s_add_u32 s32, s32, 139264
    v_lshlrev_b32 v239, 4, v239
    v_add_u32 v239, s32, v239
    v_add_u32 v238, 131072, v2
    ds_read_b64_tr_b16 v[124:125], v237 offset:0
    ds_read_b64_tr_b16 v[126:127], v237 offset:1024
    ds_read_b64_tr_b16 v[128:129], v237 offset:512
    ds_read_b64_tr_b16 v[130:131], v237 offset:1536
    ds_read_b128 v[132:135], v238 offset:0
    ds_read_b128 v[136:139], v238 offset:1024
    ds_read_b128 v[140:143], v238 offset:2048
    ds_read_b128 v[144:147], v238 offset:3072
    v_and_b32 v236, 0x33, v1
    v_bfe_u32 v212, v1, 2, 1
    v_lshl_or_b32 v236, v212, 3, v236
    v_bfe_u32 v212, v1, 3, 1
    v_lshl_or_b32 v236, v212, 2, v236
    v_lshlrev_b32 v236, 1, v236
    v_add_u32 v236, s32, v236
    s_waitcnt lgkmcnt(8)
    v_add_f32 v180, v180, v181
    v_add_f32 v180, v180, v182
    v_add_f32 v180, v180, v183
    v_add_f32 v180, v180, v184
    v_add_f32 v180, v180, v185
    v_add_f32 v180, v180, v186
    v_add_f32 v180, v180, v187
    v_cvt_pk_bf16_f32 v180, v180, v180
    ds_write_b16 v236, v180
    ds_read_b128 v[148:151], v239 offset:0
    ds_read_b128 v[152:155], v239 offset:32
    ds_read_b128 v[156:159], v239 offset:64
    ds_read_b128 v[160:163], v239 offset:96
    s_waitcnt lgkmcnt(9)
K2_S2TILE:
    v_mfma_f32_32x32x16_bf16 v[220:235], v[124:127], v[116:119], 0
    v_mfma_f32_32x32x16_bf16 v[220:235], v[128:131], v[120:123], v[220:235]
    s_cmp_eq_u32 s50, 0
    s_cbranch_scc1 K2_S2NL
    s_add_u32 s32, s37, 65536
    buffer_load_dwordx4 v[116:119], v2, s[8:11], s32 offen sc1
    buffer_load_dwordx4 v[120:123], v2, s[8:11], s32 offen offset:1024 sc1
K2_S2NL:
    s_nop 15
    v_max3_f32 v212, v220, v221, v222
    v_min3_f32 v213, v220, v221, v222
    v_max3_f32 v212, v212, v223, v224
    v_min3_f32 v213, v213, v223, v224
    v_max3_f32 v212, v212, v225, v226
    v_min3_f32 v213, v213, v225, v226
    v_max3_f32 v212, v212, v227, v228
    v_min3_f32 v213, v213, v227, v228
    v_max3_f32 v212, v212, v229, v230
    v_min3_f32 v213, v213, v229, v230
    v_max3_f32 v212, v212, v231, v232
    v_min3_f32 v213, v213, v231, v232
    v_max3_f32 v212, v212, v233, v234
    v_min3_f32 v213, v213, v233, v234
    v_max_f32 v212, v212, v235
    v_min_f32 v213, v213, v235
    v_mov_b32 v214, v212
    v_mov_b32 v215, v213
    s_nop 1
    v_permlane32_swap_b32 v212, v214
    v_permlane32_swap_b32 v213, v215
    s_nop 1
    v_max_f32 v212, v212, v214
    v_min_f32 v213, v213, v215
    v_mul_f32 v216, s90, v212
    v_mul_f32 v217, s90, v213
    v_fma_f32 v180, v220, s90, -v216
    v_fma_f32 v196, -v220, s90, v217
    v_fma_f32 v181, v221, s90, -v216
    v_fma_f32 v197, -v221, s90, v217
    v_fma_f32 v182, v222, s90, -v216
    v_fma_f32 v198, -v222, s90, v217
    v_fma_f32 v183, v223, s90, -v216
    v_fma_f32 v199, -v223, s90, v217
    v_fma_f32 v184, v224, s90, -v216
    v_fma_f32 v200, -v224, s90, v217
    v_fma_f32 v185, v225, s90, -v216
    v_fma_f32 v201, -v225, s90, v217
    v_fma_f32 v186, v226, s90, -v216
    v_fma_f32 v202, -v226, s90, v217
    v_fma_f32 v187, v227, s90, -v216
    v_fma_f32 v203, -v227, s90, v217
    v_fma_f32 v188, v228, s90, -v216
    v_fma_f32 v204, -v228, s90, v217
    v_fma_f32 v189, v229, s90, -v216
    v_fma_f32 v205, -v229, s90, v217
    v_fma_f32 v190, v230, s90, -v216
    v_fma_f32 v206, -v230, s90, v217
    v_fma_f32 v191, v231, s90, -v216
    v_fma_f32 v207, -v231, s90, v217
    v_fma_f32 v192, v232, s90, -v216
    v_fma_f32 v208, -v232, s90, v217
    v_fma_f32 v193, v233, s90, -v216
    v_fma_f32 v209, -v233, s90, v217
    v_fma_f32 v194, v234, s90, -v216
    v_fma_f32 v210, -v234, s90, v217
    v_fma_f32 v195, v235, s90, -v216
    v_fma_f32 v211, -v235, s90, v217
    v_exp_f32 v180, v180
    v_exp_f32 v181, v181
    v_exp_f32 v182, v182
    v_exp_f32 v183, v183
    v_exp_f32 v184, v184
    v_exp_f32 v185, v185
    v_exp_f32 v186, v186
    v_exp_f32 v187, v187
    v_exp_f32 v188, v188
    v_exp_f32 v189, v189
    v_exp_f32 v190, v190
    v_exp_f32 v191, v191
    v_exp_f32 v192, v192
    v_exp_f32 v193, v193
    v_exp_f32 v194, v194
    v_exp_f32 v195, v195
    v_exp_f32 v196, v196
    v_exp_f32 v197, v197
    v_exp_f32 v198, v198
    v_exp_f32 v199, v199
    v_exp_f32 v200, v200
    v_exp_f32 v201, v201
    v_exp_f32 v202, v202
    v_exp_f32 v203, v203
    v_exp_f32 v204, v204
    v_exp_f32 v205, v205
    v_exp_f32 v206, v206
    v_exp_f32 v207, v207
    v_exp_f32 v208, v208
    v_exp_f32 v209, v209
    v_exp_f32 v210, v210
    v_exp_f32 v211, v211
    v_add_f32 v212, v180, v181
    v_add_f32 v213, v196, v197
    v_add_f32 v214, v182, v183
    v_add_f32 v215, v198, v199
    v_add_f32 v212, v212, v184
    v_add_f32 v213, v213, v200
    v_add_f32 v214, v214, v185
    v_add_f32 v215, v215, v201
    v_add_f32 v212, v212, v186
    v_add_f32 v213, v213, v202
    v_add_f32 v214, v214, v187
    v_add_f32 v215, v215, v203
    v_add_f32 v212, v212, v188
    v_add_f32 v213, v213, v204
    v_add_f32 v214, v214, v189
    v_add_f32 v215, v215, v205
    v_add_f32 v212, v212, v190
    v_add_f32 v213, v213, v206
    v_add_f32 v214, v214, v191
    v_add_f32 v215, v215, v207
    v_add_f32 v212, v212, v192
    v_add_f32 v213, v213, v208
    v_add_f32 v214, v214, v193
    v_add_f32 v215, v215, v209
    v_add_f32 v212, v212, v194
    v_add_f32 v213, v213, v210
    v_add_f32 v214, v214, v195
    v_add_f32 v215, v215, v211
    v_add_f32 v216, v212, v214
    v_add_f32 v217, v213, v215
    v_mov_b32 v218, v216
    v_mov_b32 v219, v217
    s_nop 1
    v_permlane32_swap_b32 v216, v218
    v_permlane32_swap_b32 v217, v219
    s_nop 1
    v_add_f32 v216, v216, v218
    v_add_f32 v217, v217, v219
    v_rcp_f32 v216, v216
    v_rcp_f32 v217, v217
    s_nop 0
    v_mul_f32 v180, v180, v216
    v_mul_f32 v196, v196, v217
    v_mul_f32 v181, v181, v216
    v_mul_f32 v197, v197, v217
    v_mul_f32 v182, v182, v216
    v_mul_f32 v198, v198, v217
    v_mul_f32 v183, v183, v216
    v_mul_f32 v199, v199, v217
    v_mul_f32 v184, v184, v216
    v_mul_f32 v200, v200, v217
    v_mul_f32 v185, v185, v216
    v_mul_f32 v201, v201, v217
    v_mul_f32 v186, v186, v216
    v_mul_f32 v202, v202, v217
    v_mul_f32 v187, v187, v216
    v_mul_f32 v203, v203, v217
    v_mul_f32 v188, v188, v216
    v_mul_f32 v204, v204, v217
    v_mul_f32 v189, v189, v216
    v_mul_f32 v205, v205, v217
    v_mul_f32 v190, v190, v216
    v_mul_f32 v206, v206, v217
    v_mul_f32 v191, v191, v216
    v_mul_f32 v207, v207, v217
    v_mul_f32 v192, v192, v216
    v_mul_f32 v208, v208, v217
    v_mul_f32 v193, v193, v216
    v_mul_f32 v209, v209, v217
    v_mul_f32 v194, v194, v216
    v_mul_f32 v210, v210, v217
    v_mul_f32 v195, v195, v216
    v_mul_f32 v211, v211, v217
    v_cvt_pk_bf16_f32 v164, v180, v181
    v_cvt_pk_bf16_f32 v165, v182, v183
    v_cvt_pk_bf16_f32 v166, v184, v185
    v_cvt_pk_bf16_f32 v167, v186, v187
    v_cvt_pk_bf16_f32 v168, v188, v189
    v_cvt_pk_bf16_f32 v169, v190, v191
    v_cvt_pk_bf16_f32 v170, v192, v193
    v_cvt_pk_bf16_f32 v171, v194, v195
    v_cvt_pk_bf16_f32 v172, v196, v197
    v_cvt_pk_bf16_f32 v173, v198, v199
    v_cvt_pk_bf16_f32 v174, v200, v201
    v_cvt_pk_bf16_f32 v175, v202, v203
    v_cvt_pk_bf16_f32 v176, v204, v205
    v_cvt_pk_bf16_f32 v177, v206, v207
    v_cvt_pk_bf16_f32 v178, v208, v209
    v_cvt_pk_bf16_f32 v179, v210, v211
    s_waitcnt lgkmcnt(0)
    s_nop 0
    v_mfma_f32_32x32x16_bf16 v[180:195], v[148:151], v[164:167], 0
    v_mfma_f32_32x32x16_bf16 v[180:195], v[152:155], v[168:171], v[180:195]
    v_mfma_f32_32x32x16_bf16 v[180:195], v[156:159], v[172:175], v[180:195]
    v_mfma_f32_32x32x16_bf16 v[180:195], v[160:163], v[176:179], v[180:195]
    v_mfma_f32_32x32x16_bf16 v[220:235], v[132:135], v[164:167], 0
    v_mfma_f32_32x32x16_bf16 v[220:235], v[136:139], v[168:171], v[220:235]
    v_mfma_f32_32x32x16_bf16 v[220:235], v[140:143], v[172:175], v[220:235]
    v_mfma_f32_32x32x16_bf16 v[220:235], v[144:147], v[176:179], v[220:235]
    s_mov_b32 s32, 0x358637bd
    s_nop 7
    v_add_f32 v212, s32, v180
    v_rcp_f32 v212, v212
    s_nop 7
    v_mul_f32 v220, v220, v212
    v_mul_f32 v221, v221, v212
    v_mul_f32 v222, v222, v212
    v_mul_f32 v223, v223, v212
    v_mul_f32 v224, v224, v212
    v_mul_f32 v225, v225, v212
    v_mul_f32 v226, v226, v212
    v_mul_f32 v227, v227, v212
    v_mul_f32 v228, v228, v212
    v_mul_f32 v229, v229, v212
    v_mul_f32 v230, v230, v212
    v_mul_f32 v231, v231, v212
    v_mul_f32 v232, v232, v212
    v_mul_f32 v233, v233, v212
    v_mul_f32 v234, v234, v212
    v_mul_f32 v235, v235, v212
    v_cvt_pk_bf16_f32 v164, v220, v221
    v_cvt_pk_bf16_f32 v165, v222, v223
    v_cvt_pk_bf16_f32 v166, v224, v225
    v_cvt_pk_bf16_f32 v167, v226, v227
    v_cvt_pk_bf16_f32 v168, v228, v229
    v_cvt_pk_bf16_f32 v169, v230, v231
    v_cvt_pk_bf16_f32 v170, v232, v233
    v_cvt_pk_bf16_f32 v171, v234, v235
    buffer_store_dwordx4 v[164:167], v2, s[8:11], s51 offen sc1
    buffer_store_dwordx4 v[168:171], v2, s[8:11], s51 offen offset:1024 sc1
    s_cmp_eq_u32 s50, 0
    s_cbranch_scc1 K2_LOOP
    s_mov_b32 s50, 0
    s_add_u32 s51, s51, 2097152
    s_waitcnt vmcnt(2)
    s_branch K2_S2TILE
    s_branch K2_LOOP
K2_DONE:
    s_waitcnt lgkmcnt(0)
    v_mfma_f32_32x32x16_bf16 v[76:91], v[112:115], v[72:75], v[76:91]
    v_mfma_f32_16x16x32_bf16 v[92:95], v[96:99], v[72:75], v[92:95]
    s_nop 15
    s_nop 3
    s_mov_b32 s32, 0x17800000
    s_mov_b32 s33, 0x76800000
    v_cmp_nge_f32 s[40:41], v92, s32
    v_cmp_nle_f32 vcc, v92, s33
    s_or_b64 s[40:41], s[40:41], vcc
    v_mul_f32 v5, 0, v76
    v_fma_f32 v5, v77, 0, v5
    v_fma_f32 v5, v78, 0, v5
    v_fma_f32 v5, v79, 0, v5
    v_fma_f32 v5, v80, 0, v5
    v_fma_f32 v5, v81, 0, v5
    v_fma_f32 v5, v82, 0, v5
    v_fma_f32 v5, v83, 0, v5
    v_fma_f32 v5, v84, 0, v5
    v_fma_f32 v5, v85, 0, v5
    v_fma_f32 v5, v86, 0, v5
    v_fma_f32 v5, v87, 0, v5
    v_fma_f32 v5, v88, 0, v5
    v_fma_f32 v5, v89, 0, v5
    v_fma_f32 v5, v90, 0, v5
    v_fma_f32 v5, v91, 0, v5
    v_cmp_u_f32 vcc, v5, v5
    s_or_b64 s[40:41], s[40:41], vcc
    s_cmp_lg_u64 s[40:41], 0
    s_cbranch_scc1 K2_SLOW
K2_FIN:
    v_rcp_f32 v5, v92
    s_nop 0
    v_mul_f32 v76, v76, v5
    v_mul_f32 v77, v77, v5
    v_mul_f32 v78, v78, v5
    v_mul_f32 v79, v79, v5
    v_mul_f32 v80, v80, v5
    v_mul_f32 v81, v81, v5
    v_mul_f32 v82, v82, v5
    v_mul_f32 v83, v83, v5
    v_mul_f32 v84, v84, v5
    v_mul_f32 v85, v85, v5
    v_mul_f32 v86, v86, v5
    v_mul_f32 v87, v87, v5
    v_mul_f32 v88, v88, v5
    v_mul_f32 v89, v89, v5
    v_mul_f32 v90, v90, v5
    v_mul_f32 v91, v91, v5
    v_cvt_pk_bf16_f32 v68, v76, v77
    v_cvt_pk_bf16_f32 v69, v78, v79
    v_cvt_pk_bf16_f32 v70, v80, v81
    v_cvt_pk_bf16_f32 v71, v82, v83
    v_cvt_pk_bf16_f32 v72, v84, v85
    v_cvt_pk_bf16_f32 v73, v86, v87
    v_cvt_pk_bf16_f32 v74, v88, v89
    v_cvt_pk_bf16_f32 v75, v90, v91
    buffer_store_dwordx4 v[68:71], v2, s[8:11], s36 offen sc1
    buffer_store_dwordx4 v[72:75], v2, s[8:11], s36 offen offset:1024 sc1
    s_waitcnt vmcnt(0) lgkmcnt(0)
    s_barrier
    s_cmp_lg_u32 s22, 4
    s_cbranch_scc1 K2_PUBA
    s_lshl_b32 s32, s21, 5
    s_add_u32 s32, s32, s20
    s_lshl_b32 s32, s32, 2
    s_add_u32 s32, s32, 19922944
    v_mov_b32 v238, 0
    v_mov_b32 v239, s88
    s_mov_b64 exec, 1
    buffer_store_dword v239, v238, s[8:11], s32 offen sc1
    s_mov_b64 exec, -1
K2_PUBA:
    s_branch K3_BEGIN
K2_SLOW:
    v_mov_b32 v5, 0xff800000
    v_mov_b32 v6, 0
    v_mov_b32 v76, 0
    v_mov_b32 v77, 0
    v_mov_b32 v78, 0
    v_mov_b32 v79, 0
    v_mov_b32 v80, 0
    v_mov_b32 v81, 0
    v_mov_b32 v82, 0
    v_mov_b32 v83, 0
    v_mov_b32 v84, 0
    v_mov_b32 v85, 0
    v_mov_b32 v86, 0
    v_mov_b32 v87, 0
    v_mov_b32 v88, 0
    v_mov_b32 v89, 0
    v_mov_b32 v90, 0
    v_mov_b32 v91, 0
    s_mov_b32 s32, 0
K2_SLOW_LOOP:
    buffer_load_dwordx4 v[20:23], v2, s[4:7], s32 offen offset:0 sc1
    buffer_load_dwordx4 v[24:27], v2, s[4:7], s32 offen offset:1024 sc1
    buffer_load_dwordx4 v[28:31], v2, s[4:7], s32 offen offset:2048 sc1
    buffer_load_dwordx4 v[32:35], v2, s[4:7], s32 offen offset:3072 sc1
    s_waitcnt vmcnt(0)
    v_mfma_f32_32x32x16_bf16 v[36:51], v[20:23], v[12:15], 0
    v_mfma_f32_32x32x16_bf16 v[36:51], v[24:27], v[16:19], v[36:51]
    s_nop 15
    s_nop 3
    v_max3_f32 v7, v36, v37, v5
    v_max3_f32 v7, v38, v39, v7
    v_max3_f32 v7, v40, v41, v7
    v_max3_f32 v7, v42, v43, v7
    v_max3_f32 v7, v44, v45, v7
    v_max3_f32 v7, v46, v47, v7
    v_max3_f32 v7, v48, v49, v7
    v_max3_f32 v7, v50, v51, v7
    v_mov_b32 v9, v7
    s_nop 1
    v_permlane32_swap_b32 v7, v9
    s_nop 1
    v_max_f32 v7, v7, v9
    v_sub_f32 v8, v5, v7
    v_exp_f32 v8, v8
    v_mov_b32 v5, v7
    v_sub_f32 v36, v36, v7
    v_sub_f32 v37, v37, v7
    v_sub_f32 v38, v38, v7
    v_sub_f32 v39, v39, v7
    v_sub_f32 v40, v40, v7
    v_sub_f32 v41, v41, v7
    v_sub_f32 v42, v42, v7
    v_sub_f32 v43, v43, v7
    v_sub_f32 v44, v44, v7
    v_sub_f32 v45, v45, v7
    v_sub_f32 v46, v46, v7
    v_sub_f32 v47, v47, v7
    v_sub_f32 v48, v48, v7
    v_sub_f32 v49, v49, v7
    v_sub_f32 v50, v50, v7
    v_sub_f32 v51, v51, v7
    v_exp_f32 v36, v36
    v_exp_f32 v37, v37
    v_exp_f32 v38, v38
    v_exp_f32 v39, v39
    v_exp_f32 v40, v40
    v_exp_f32 v41, v41
    v_exp_f32 v42, v42
    v_exp_f32 v43, v43
    v_exp_f32 v44, v44
    v_exp_f32 v45, v45
    v_exp_f32 v46, v46
    v_exp_f32 v47, v47
    v_exp_f32 v48, v48
    v_exp_f32 v49, v49
    v_exp_f32 v50, v50
    v_exp_f32 v51, v51
    v_mul_f32 v6, v6, v8
    v_mul_f32 v76, v76, v8
    v_mul_f32 v77, v77, v8
    v_mul_f32 v78, v78, v8
    v_mul_f32 v79, v79, v8
    v_mul_f32 v80, v80, v8
    v_mul_f32 v81, v81, v8
    v_mul_f32 v82, v82, v8
    v_mul_f32 v83, v83, v8
    v_mul_f32 v84, v84, v8
    v_mul_f32 v85, v85, v8
    v_mul_f32 v86, v86, v8
    v_mul_f32 v87, v87, v8
    v_mul_f32 v88, v88, v8
    v_mul_f32 v89, v89, v8
    v_mul_f32 v90, v90, v8
    v_mul_f32 v91, v91, v8
    v_add_f32 v6, v6, v36
    v_add_f32 v6, v6, v37
    v_add_f32 v6, v6, v38
    v_add_f32 v6, v6, v39
    v_add_f32 v6, v6, v40
    v_add_f32 v6, v6, v41
    v_add_f32 v6, v6, v42
    v_add_f32 v6, v6, v43
    v_add_f32 v6, v6, v44
    v_add_f32 v6, v6, v45
    v_add_f32 v6, v6, v46
    v_add_f32 v6, v6, v47
    v_add_f32 v6, v6, v48
    v_add_f32 v6, v6, v49
    v_add_f32 v6, v6, v50
    v_add_f32 v6, v6, v51
    v_cvt_pk_bf16_f32 v68, v36, v37
    v_cvt_pk_bf16_f32 v69, v38, v39
    v_cvt_pk_bf16_f32 v70, v40, v41
    v_cvt_pk_bf16_f32 v71, v42, v43
    v_cvt_pk_bf16_f32 v72, v44, v45
    v_cvt_pk_bf16_f32 v73, v46, v47
    v_cvt_pk_bf16_f32 v74, v48, v49
    v_cvt_pk_bf16_f32 v75, v50, v51
    s_nop 1
    v_mfma_f32_32x32x16_bf16 v[76:91], v[28:31], v[68:71], v[76:91]
    v_mfma_f32_32x32x16_bf16 v[76:91], v[32:35], v[72:75], v[76:91]
    s_nop 15
    s_nop 3
    s_add_u32 s32, s32, 4096
    s_cmp_lt_u32 s32, 262144
    s_cbranch_scc1 K2_SLOW_LOOP
    v_mov_b32 v9, v6
    s_nop 1
    v_permlane32_swap_b32 v6, v9
    s_nop 1
    v_add_f32 v92, v6, v9
    s_branch K2_FIN
K3_BEGIN:
    s_lshr_b32 s26, s22, 2
    v_bfe_u32 v9, v1, 2, 2
    v_lshrrev_b32 v10, 5, v1
    v_lshl_add_u32 v11, v10, 2, v9
    v_lshlrev_b32 v5, 7, v11
    v_and_b32 v11, 1, v1
    v_lshlrev_b32 v11, 2, v11
    v_bfe_u32 v12, v1, 4, 1
    v_add_u32 v11, v11, v12
    v_and_b32 v12, 2, v9
    v_xor_b32 v11, v11, v12
    v_lshl_add_u32 v5, v11, 4, v5
    v_bfe_u32 v11, v1, 1, 1
    v_lshl_add_u32 v5, v11, 3, v5
    s_lshl_b32 s32, s26, 13
    v_add_u32 v5, s32, v5
    v_xor_b32 v6, 32, v5
    v_add_u32 v7, 131072, v5
    v_add_u32 v8, 131072, v6
    ds_read_b64_tr_b16 v[100:101], v5 offset:0
    ds_read_b64_tr_b16 v[102:103], v5 offset:1024
    ds_read_b64_tr_b16 v[104:105], v6 offset:0
    ds_read_b64_tr_b16 v[106:107], v6 offset:1024
    ds_read_b64_tr_b16 v[108:109], v5 offset:2048
    ds_read_b64_tr_b16 v[110:111], v5 offset:3072
    ds_read_b64_tr_b16 v[112:113], v6 offset:2048
    ds_read_b64_tr_b16 v[114:115], v6 offset:3072
    ds_read_b64_tr_b16 v[116:117], v5 offset:4096
    ds_read_b64_tr_b16 v[118:119], v5 offset:5120
    ds_read_b64_tr_b16 v[120:121], v6 offset:4096
    ds_read_b64_tr_b16 v[122:123], v6 offset:5120
    ds_read_b64_tr_b16 v[124:125], v5 offset:6144
    ds_read_b64_tr_b16 v[126:127], v5 offset:7168
    ds_read_b64_tr_b16 v[128:129], v6 offset:6144
    ds_read_b64_tr_b16 v[130:131], v6 offset:7168
    ds_read_b64_tr_b16 v[132:133], v5 offset:16384
    ds_read_b64_tr_b16 v[134:135], v5 offset:17408
    ds_read_b64_tr_b16 v[136:137], v6 offset:16384
    ds_read_b64_tr_b16 v[138:139], v6 offset:17408
    ds_read_b64_tr_b16 v[140:141], v5 offset:18432
    ds_read_b64_tr_b16 v[142:143], v5 offset:19456
    ds_read_b64_tr_b16 v[144:145], v6 offset:18432
    ds_read_b64_tr_b16 v[146:147], v6 offset:19456
    ds_read_b64_tr_b16 v[148:149], v5 offset:20480
    ds_read_b64_tr_b16 v[150:151], v5 offset:21504
    ds_read_b64_tr_b16 v[152:153], v6 offset:20480
    ds_read_b64_tr_b16 v[154:155], v6 offset:21504
    ds_read_b64_tr_b16 v[156:157], v5 offset:22528
    ds_read_b64_tr_b16 v[158:159], v5 offset:23552
    ds_read_b64_tr_b16 v[160:161], v6 offset:22528
    ds_read_b64_tr_b16 v[162:163], v6 offset:23552
    ds_read_b64_tr_b16 v[164:165], v7 offset:0
    ds_read_b64_tr_b16 v[166:167], v7 offset:1024
    ds_read_b64_tr_b16 v[168:169], v8 offset:0
    ds_read_b64_tr_b16 v[170:171], v8 offset:1024
    ds_read_b64_tr_b16 v[172:173], v7 offset:2048
    ds_read_b64_tr_b16 v[174:175], v7 offset:3072
    ds_read_b64_tr_b16 v[176:177], v8 offset:2048
    ds_read_b64_tr_b16 v[178:179], v8 offset:3072
    ds_read_b64_tr_b16 v[180:181], v7 offset:4096
    ds_read_b64_tr_b16 v[182:183], v7 offset:5120
    ds_read_b64_tr_b16 v[184:185], v8 offset:4096
    ds_read_b64_tr_b16 v[186:187], v8 offset:5120
    ds_read_b64_tr_b16 v[188:189], v7 offset:6144
    ds_read_b64_tr_b16 v[190:191], v7 offset:7168
    ds_read_b64_tr_b16 v[192:193], v8 offset:6144
    ds_read_b64_tr_b16 v[194:195], v8 offset:7168
    ds_read_b64_tr_b16 v[196:197], v7 offset:16384
    ds_read_b64_tr_b16 v[198:199], v7 offset:17408
    ds_read_b64_tr_b16 v[200:201], v8 offset:16384
    ds_read_b64_tr_b16 v[202:203], v8 offset:17408
    ds_read_b64_tr_b16 v[204:205], v7 offset:18432
    ds_read_b64_tr_b16 v[206:207], v7 offset:19456
    ds_read_b64_tr_b16 v[208:209], v8 offset:18432
    ds_read_b64_tr_b16 v[210:211], v8 offset:19456
    ds_read_b64_tr_b16 v[212:213], v7 offset:20480
    ds_read_b64_tr_b16 v[214:215], v7 offset:21504
    ds_read_b64_tr_b16 v[216:217], v8 offset:20480
    ds_read_b64_tr_b16 v[218:219], v8 offset:21504
    ds_read_b64_tr_b16 v[220:221], v7 offset:22528
    ds_read_b64_tr_b16 v[222:223], v7 offset:23552
    ds_read_b64_tr_b16 v[224:225], v8 offset:22528
    ds_read_b64_tr_b16 v[226:227], v8 offset:23552
    s_waitcnt lgkmcnt(0)
    s_barrier
    s_add_u32 m0, s49, 0
    s_add_u32 s32, s48, 786432
    buffer_load_dwordx4 v244, s[16:19], s32 offen lds
    s_add_u32 m0, s49, 1024
    s_add_u32 s32, s48, 802816
    buffer_load_dwordx4 v244, s[16:19], s32 offen lds
    s_add_u32 m0, s49, 16384
    s_add_u32 s32, s48, 917504
    buffer_load_dwordx4 v244, s[16:19], s32 offen lds
    s_add_u32 m0, s49, 17408
    s_add_u32 s32, s48, 933888
    buffer_load_dwordx4 v244, s[16:19], s32 offen lds
    s_add_u32 m0, s49, 131072
    s_add_u32 s32, s48, 1048576
    buffer_load_dwordx4 v244, s[16:19], s32 offen lds
    s_add_u32 m0, s49, 132096
    s_add_u32 s32, s48, 1064960
    buffer_load_dwordx4 v244, s[16:19], s32 offen lds
    s_add_u32 m0, s49, 147456
    s_add_u32 s32, s48, 1179648
    buffer_load_dwordx4 v244, s[16:19], s32 offen lds
    s_add_u32 m0, s49, 148480
    s_add_u32 s32, s48, 1196032
    buffer_load_dwordx4 v244, s[16:19], s32 offen lds
    s_bfe_u32 s20, s2, 0x10002
    s_bfe_u32 s34, s2, 0x10001
    s_lshl_b32 s34, s34, 3
    s_bfe_u32 s35, s2, 0x30003
    s_add_u32 s21, s34, s35
    s_xor_b32 s32, s20, 1
    s_lshr_b32 s33, s21, s32
    s_lshl_b32 s33, s33, 7
    s_lshl_b32 s32, s20, 10
    s_add_u32 s33, s33, s32
    s_add_u32 s33, s33, 19922944
    v_lshlrev_b32 v9, 2, v1
    s_cmp_lg_u32 s22, 4
    s_cbranch_scc1 K3_W1
    s_mov_b32 s32, 0
    s_mov_b32 exec_hi, 0
POLL_O:
    buffer_load_dword v10, v9, s[8:11], s33 offen sc1
    s_waitcnt vmcnt(0)
    v_cmp_ne_u32 vcc, s88, v10
    s_add_u32 s32, s32, 1
    s_nop 3
    s_cbranch_vccz POLL_O_OK
    s_sleep 4
    s_cmp_lt_u32 s32, 1000000
    s_cbranch_scc1 POLL_O
POLL_O_OK:
    s_mov_b64 exec, -1
K3_W1:
    s_and_b32 s34, s2, 1
    s_lshl_b32 s34, s34, 2
    s_lshr_b32 s35, s2, 6
    s_add_u32 s24, s34, s35
    s_and_b32 s25, s22, 3
    s_lshr_b32 s26, s22, 2
    s_lshr_b32 s32, s22, 1
    s_lshl_b32 s30, s32, 16
    s_and_b32 s33, s22, 1
    s_lshl_b32 s33, s33, 11
    s_add_u32 s30, s30, s33
    s_lshl_b32 s34, s20, 22
    s_lshl_b32 s35, s21, 18
    s_add_u32 s34, s34, s35
    s_add_u32 s34, s34, 20971520
    s_add_u32 s34, s8, s34
    s_addc_u32 s35, s9, 0
    s_mov_b32 s4, s34
    s_mov_b32 s5, s35
    s_mov_b32 s6, 262144
    s_mov_b32 s7, 0x00020000
    s_barrier
    s_add_u32 m0, s49, 65536
    s_add_u32 s32, s30, 0
    buffer_load_dwordx4 v2, s[4:7], s32 offen sc1 lds
    buffer_load_dwordx4 v2, s[4:7], s32 offen offset:1024 sc1 lds
    s_add_u32 m0, s49, 81920
    s_add_u32 s32, s30, 4096
    buffer_load_dwordx4 v2, s[4:7], s32 offen sc1 lds
    buffer_load_dwordx4 v2, s[4:7], s32 offen offset:1024 sc1 lds
    s_add_u32 m0, s49, 98304
    s_add_u32 s32, s30, 8192
    buffer_load_dwordx4 v2, s[4:7], s32 offen sc1 lds
    buffer_load_dwordx4 v2, s[4:7], s32 offen offset:1024 sc1 lds
    s_add_u32 m0, s49, 114688
    s_add_u32 s32, s30, 12288
    buffer_load_dwordx4 v2, s[4:7], s32 offen sc1 lds
    buffer_load_dwordx4 v2, s[4:7], s32 offen offset:1024 sc1 lds
    s_lshl_b32 s32, s25, 12
    s_add_u32 s32, s32, 65536
    v_add_u32 v4, s32, v2
    v_mov_b32 v16, 0
    v_mov_b32 v17, 0
    v_mov_b32 v18, 0
    v_mov_b32 v19, 0
    v_mov_b32 v20, 0
    v_mov_b32 v21, 0
    v_mov_b32 v22, 0
    v_mov_b32 v23, 0
    v_mov_b32 v24, 0
    v_mov_b32 v25, 0
    v_mov_b32 v26, 0
    v_mov_b32 v27, 0
    v_mov_b32 v28, 0
    v_mov_b32 v29, 0
    v_mov_b32 v30, 0
    v_mov_b32 v31, 0
    v_mov_b32 v32, 0
    v_mov_b32 v33, 0
    v_mov_b32 v34, 0
    v_mov_b32 v35, 0
    v_mov_b32 v36, 0
    v_mov_b32 v37, 0
    v_mov_b32 v38, 0
    v_mov_b32 v39, 0
    v_mov_b32 v40, 0
    v_mov_b32 v41, 0
    v_mov_b32 v42, 0
    v_mov_b32 v43, 0
    v_mov_b32 v44, 0
    v_mov_b32 v45, 0
    v_mov_b32 v46, 0
    v_mov_b32 v47, 0
    s_waitcnt vmcnt(6) lgkmcnt(0)
    s_mov_b32 s12, s60
    s_mov_b32 s13, s61
    s_mov_b32 s14, 8388608
    s_mov_b32 s15, 0x00020000
    s_barrier
    ds_read_b128 v[48:51], v4 offset:0
    ds_read_b128 v[60:63], v4 offset:1024
    s_waitcnt lgkmcnt(0)
    v_mfma_f32_32x32x16_bf16 v[16:31], v[100:103], v[48:51], v[16:31]
    ds_read_b128 v[72:75], v4 offset:2048
    ds_read_b128 v[84:87], v4 offset:3072
    v_mfma_f32_32x32x16_bf16 v[32:47], v[104:107], v[48:51], v[32:47]
    v_mfma_f32_32x32x16_bf16 v[16:31], v[108:111], v[60:63], v[16:31]
    v_mfma_f32_32x32x16_bf16 v[32:47], v[112:115], v[60:63], v[32:47]
    s_waitcnt vmcnt(4) lgkmcnt(0)
    s_barrier
    v_mfma_f32_32x32x16_bf16 v[16:31], v[116:119], v[72:75], v[16:31]
    ds_read_b128 v[48:51], v4 offset:16384
    ds_read_b128 v[60:63], v4 offset:17408
    v_mfma_f32_32x32x16_bf16 v[32:47], v[120:123], v[72:75], v[32:47]
    v_mfma_f32_32x32x16_bf16 v[16:31], v[124:127], v[84:87], v[16:31]
    v_mfma_f32_32x32x16_bf16 v[32:47], v[128:131], v[84:87], v[32:47]
    s_add_u32 m0, s49, 65536
    s_add_u32 s32, s30, 16384
    buffer_load_dwordx4 v2, s[4:7], s32 offen sc1 lds
    buffer_load_dwordx4 v2, s[4:7], s32 offen offset:1024 sc1 lds
    s_waitcnt lgkmcnt(0)
    v_mfma_f32_32x32x16_bf16 v[16:31], v[132:135], v[48:51], v[16:31]
    ds_read_b128 v[72:75], v4 offset:18432
    ds_read_b128 v[84:87], v4 offset:19456
    v_mfma_f32_32x32x16_bf16 v[32:47], v[136:139], v[48:51], v[32:47]
    v_mfma_f32_32x32x16_bf16 v[16:31], v[140:143], v[60:63], v[16:31]
    v_mfma_f32_32x32x16_bf16 v[32:47], v[144:147], v[60:63], v[32:47]
    s_waitcnt vmcnt(4) lgkmcnt(0)
    s_barrier
    v_mfma_f32_32x32x16_bf16 v[16:31], v[148:151], v[72:75], v[16:31]
    ds_read_b128 v[48:51], v4 offset:32768
    ds_read_b128 v[60:63], v4 offset:33792
    v_mfma_f32_32x32x16_bf16 v[32:47], v[152:155], v[72:75], v[32:47]
    v_mfma_f32_32x32x16_bf16 v[16:31], v[156:159], v[84:87], v[16:31]
    v_mfma_f32_32x32x16_bf16 v[32:47], v[160:163], v[84:87], v[32:47]
    s_add_u32 m0, s49, 81920
    s_add_u32 s32, s30, 20480
    buffer_load_dwordx4 v2, s[4:7], s32 offen sc1 lds
    buffer_load_dwordx4 v2, s[4:7], s32 offen offset:1024 sc1 lds
    s_waitcnt lgkmcnt(0)
    v_mfma_f32_32x32x16_bf16 v[16:31], v[164:167], v[48:51], v[16:31]
    ds_read_b128 v[72:75], v4 offset:34816
    ds_read_b128 v[84:87], v4 offset:35840
    v_mfma_f32_32x32x16_bf16 v[32:47], v[168:171], v[48:51], v[32:47]
    v_mfma_f32_32x32x16_bf16 v[16:31], v[172:175], v[60:63], v[16:31]
    v_mfma_f32_32x32x16_bf16 v[32:47], v[176:179], v[60:63], v[32:47]
    s_waitcnt vmcnt(4) lgkmcnt(0)
    s_barrier
    v_mfma_f32_32x32x16_bf16 v[16:31], v[180:183], v[72:75], v[16:31]
    ds_read_b128 v[48:51], v4 offset:49152
    ds_read_b128 v[60:63], v4 offset:50176
    v_mfma_f32_32x32x16_bf16 v[32:47], v[184:187], v[72:75], v[32:47]
    v_mfma_f32_32x32x16_bf16 v[16:31], v[188:191], v[84:87], v[16:31]
    v_mfma_f32_32x32x16_bf16 v[32:47], v[192:195], v[84:87], v[32:47]
    s_add_u32 m0, s49, 98304
    s_add_u32 s32, s30, 24576
    buffer_load_dwordx4 v2, s[4:7], s32 offen sc1 lds
    buffer_load_dwordx4 v2, s[4:7], s32 offen offset:1024 sc1 lds
    s_waitcnt lgkmcnt(0)
    v_mfma_f32_32x32x16_bf16 v[16:31], v[196:199], v[48:51], v[16:31]
    ds_read_b128 v[72:75], v4 offset:51200
    ds_read_b128 v[84:87], v4 offset:52224
    v_mfma_f32_32x32x16_bf16 v[32:47], v[200:203], v[48:51], v[32:47]
    v_mfma_f32_32x32x16_bf16 v[16:31], v[204:207], v[60:63], v[16:31]
    v_mfma_f32_32x32x16_bf16 v[32:47], v[208:211], v[60:63], v[32:47]
    s_waitcnt vmcnt(4) lgkmcnt(0)
    s_barrier
    v_mfma_f32_32x32x16_bf16 v[16:31], v[212:215], v[72:75], v[16:31]
    ds_read_b128 v[48:51], v4 offset:0
    ds_read_b64_tr_b16 v[52:53], v5 offset:32768
    ds_read_b64_tr_b16 v[54:55], v5 offset:33792
    ds_read_b64_tr_b16 v[56:57], v6 offset:32768
    v_mfma_f32_32x32x16_bf16 v[32:47], v[216:219], v[72:75], v[32:47]
    ds_read_b64_tr_b16 v[58:59], v6 offset:33792
    ds_read_b128 v[60:63], v4 offset:1024
    ds_read_b64_tr_b16 v[64:65], v5 offset:34816
    v_mfma_f32_32x32x16_bf16 v[16:31], v[220:223], v[84:87], v[16:31]
    ds_read_b64_tr_b16 v[66:67], v5 offset:35840
    ds_read_b64_tr_b16 v[68:69], v6 offset:34816
    ds_read_b64_tr_b16 v[70:71], v6 offset:35840
    v_mfma_f32_32x32x16_bf16 v[32:47], v[224:227], v[84:87], v[32:47]
    s_add_u32 m0, s49, 114688
    s_add_u32 s32, s30, 28672
    buffer_load_dwordx4 v2, s[4:7], s32 offen sc1 lds
    buffer_load_dwordx4 v2, s[4:7], s32 offen offset:1024 sc1 lds
    s_waitcnt lgkmcnt(0)
    v_mfma_f32_32x32x16_bf16 v[16:31], v[52:55], v[48:51], v[16:31]
    ds_read_b128 v[72:75], v4 offset:2048
    ds_read_b64_tr_b16 v[76:77], v5 offset:36864
    ds_read_b64_tr_b16 v[78:79], v5 offset:37888
    ds_read_b64_tr_b16 v[80:81], v6 offset:36864
    v_mfma_f32_32x32x16_bf16 v[32:47], v[56:59], v[48:51], v[32:47]
    ds_read_b64_tr_b16 v[82:83], v6 offset:37888
    ds_read_b128 v[84:87], v4 offset:3072
    ds_read_b64_tr_b16 v[88:89], v5 offset:38912
    v_mfma_f32_32x32x16_bf16 v[16:31], v[64:67], v[60:63], v[16:31]
    ds_read_b64_tr_b16 v[90:91], v5 offset:39936
    ds_read_b64_tr_b16 v[92:93], v6 offset:38912
    ds_read_b64_tr_b16 v[94:95], v6 offset:39936
    v_mfma_f32_32x32x16_bf16 v[32:47], v[68:71], v[60:63], v[32:47]
    s_waitcnt vmcnt(4) lgkmcnt(0)
    s_barrier
    v_mfma_f32_32x32x16_bf16 v[16:31], v[76:79], v[72:75], v[16:31]
    ds_read_b128 v[48:51], v4 offset:16384
    ds_read_b64_tr_b16 v[52:53], v5 offset:49152
    ds_read_b64_tr_b16 v[54:55], v5 offset:50176
    ds_read_b64_tr_b16 v[56:57], v6 offset:49152
    v_mfma_f32_32x32x16_bf16 v[32:47], v[80:83], v[72:75], v[32:47]
    ds_read_b64_tr_b16 v[58:59], v6 offset:50176
    ds_read_b128 v[60:63], v4 offset:17408
    ds_read_b64_tr_b16 v[64:65], v5 offset:51200
    v_mfma_f32_32x32x16_bf16 v[16:31], v[88:91], v[84:87], v[16:31]
    ds_read_b64_tr_b16 v[66:67], v5 offset:52224
    ds_read_b64_tr_b16 v[68:69], v6 offset:51200
    ds_read_b64_tr_b16 v[70:71], v6 offset:52224
    v_mfma_f32_32x32x16_bf16 v[32:47], v[92:95], v[84:87], v[32:47]
    s_add_u32 m0, s49, 65536
    s_add_u32 s32, s30, 32768
    buffer_load_dwordx4 v2, s[4:7], s32 offen sc1 lds
    buffer_load_dwordx4 v2, s[4:7], s32 offen offset:1024 sc1 lds
    s_add_u32 m0, s49, 32768
    s_add_u32 s32, s48, 1310720
    buffer_load_dwordx4 v244, s[16:19], s32 offen lds
    s_add_u32 m0, s49, 33792
    s_add_u32 s32, s48, 1327104
    buffer_load_dwordx4 v244, s[16:19], s32 offen lds
    s_waitcnt lgkmcnt(0)
    v_mfma_f32_32x32x16_bf16 v[16:31], v[52:55], v[48:51], v[16:31]
    ds_read_b128 v[72:75], v4 offset:18432
    ds_read_b64_tr_b16 v[76:77], v5 offset:53248
    ds_read_b64_tr_b16 v[78:79], v5 offset:54272
    ds_read_b64_tr_b16 v[80:81], v6 offset:53248
    v_mfma_f32_32x32x16_bf16 v[32:47], v[56:59], v[48:51], v[32:47]
    ds_read_b64_tr_b16 v[82:83], v6 offset:54272
    ds_read_b128 v[84:87], v4 offset:19456
    ds_read_b64_tr_b16 v[88:89], v5 offset:55296
    v_mfma_f32_32x32x16_bf16 v[16:31], v[64:67], v[60:63], v[16:31]
    ds_read_b64_tr_b16 v[90:91], v5 offset:56320
    ds_read_b64_tr_b16 v[92:93], v6 offset:55296
    ds_read_b64_tr_b16 v[94:95], v6 offset:56320
    v_mfma_f32_32x32x16_bf16 v[32:47], v[68:71], v[60:63], v[32:47]
    s_waitcnt vmcnt(6) lgkmcnt(0)
    s_barrier
    v_mfma_f32_32x32x16_bf16 v[16:31], v[76:79], v[72:75], v[16:31]
    ds_read_b128 v[48:51], v4 offset:32768
    ds_read_b64_tr_b16 v[52:53], v5 offset:0
    ds_read_b64_tr_b16 v[54:55], v5 offset:1024
    ds_read_b64_tr_b16 v[56:57], v6 offset:0
    v_mfma_f32_32x32x16_bf16 v[32:47], v[80:83], v[72:75], v[32:47]
    ds_read_b64_tr_b16 v[58:59], v6 offset:1024
    ds_read_b128 v[60:63], v4 offset:33792
    ds_read_b64_tr_b16 v[64:65], v5 offset:2048
    v_mfma_f32_32x32x16_bf16 v[16:31], v[88:91], v[84:87], v[16:31]
    ds_read_b64_tr_b16 v[66:67], v5 offset:3072
    ds_read_b64_tr_b16 v[68:69], v6 offset:2048
    ds_read_b64_tr_b16 v[70:71], v6 offset:3072
    v_mfma_f32_32x32x16_bf16 v[32:47], v[92:95], v[84:87], v[32:47]
    s_add_u32 m0, s49, 81920
    s_add_u32 s32, s30, 36864
    buffer_load_dwordx4 v2, s[4:7], s32 offen sc1 lds
    buffer_load_dwordx4 v2, s[4:7], s32 offen offset:1024 sc1 lds
    s_add_u32 m0, s49, 49152
    s_add_u32 s32, s48, 1441792
    buffer_load_dwordx4 v244, s[16:19], s32 offen lds
    s_add_u32 m0, s49, 50176
    s_add_u32 s32, s48, 1458176
    buffer_load_dwordx4 v244, s[16:19], s32 offen lds
    s_waitcnt lgkmcnt(0)
    v_mfma_f32_32x32x16_bf16 v[16:31], v[52:55], v[48:51], v[16:31]
    ds_read_b128 v[72:75], v4 offset:34816
    ds_read_b64_tr_b16 v[76:77], v5 offset:4096
    ds_read_b64_tr_b16 v[78:79], v5 offset:5120
    ds_read_b64_tr_b16 v[80:81], v6 offset:4096
    v_mfma_f32_32x32x16_bf16 v[32:47], v[56:59], v[48:51], v[32:47]
    ds_read_b64_tr_b16 v[82:83], v6 offset:5120
    ds_read_b128 v[84:87], v4 offset:35840
    ds_read_b64_tr_b16 v[88:89], v5 offset:6144
    v_mfma_f32_32x32x16_bf16 v[16:31], v[64:67], v[60:63], v[16:31]
    ds_read_b64_tr_b16 v[90:91], v5 offset:7168
    ds_read_b64_tr_b16 v[92:93], v6 offset:6144
    ds_read_b64_tr_b16 v[94:95], v6 offset:7168
    v_mfma_f32_32x32x16_bf16 v[32:47], v[68:71], v[60:63], v[32:47]
    s_waitcnt vmcnt(8) lgkmcnt(0)
    s_barrier
    v_mfma_f32_32x32x16_bf16 v[16:31], v[76:79], v[72:75], v[16:31]
    ds_read_b128 v[48:51], v4 offset:49152
    ds_read_b64_tr_b16 v[52:53], v5 offset:16384
    ds_read_b64_tr_b16 v[54:55], v5 offset:17408
    ds_read_b64_tr_b16 v[56:57], v6 offset:16384
    v_mfma_f32_32x32x16_bf16 v[32:47], v[80:83], v[72:75], v[32:47]
    ds_read_b64_tr_b16 v[58:59], v6 offset:17408
    ds_read_b128 v[60:63], v4 offset:50176
    ds_read_b64_tr_b16 v[64:65], v5 offset:18432
    v_mfma_f32_32x32x16_bf16 v[16:31], v[88:91], v[84:87], v[16:31]
    ds_read_b64_tr_b16 v[66:67], v5 offset:19456
    ds_read_b64_tr_b16 v[68:69], v6 offset:18432
    ds_read_b64_tr_b16 v[70:71], v6 offset:19456
    v_mfma_f32_32x32x16_bf16 v[32:47], v[92:95], v[84:87], v[32:47]
    s_add_u32 m0, s49, 98304
    s_add_u32 s32, s30, 40960
    buffer_load_dwordx4 v2, s[4:7], s32 offen sc1 lds
    buffer_load_dwordx4 v2, s[4:7], s32 offen offset:1024 sc1 lds
    s_add_u32 m0, s49, 0
    s_add_u32 s32, s48, 1572864
    buffer_load_dwordx4 v244, s[16:19], s32 offen lds
    s_add_u32 m0, s49, 1024
    s_add_u32 s32, s48, 1589248
    buffer_load_dwordx4 v244, s[16:19], s32 offen lds
    s_waitcnt lgkmcnt(0)
    v_mfma_f32_32x32x16_bf16 v[16:31], v[52:55], v[48:51], v[16:31]
    ds_read_b128 v[72:75], v4 offset:51200
    ds_read_b64_tr_b16 v[76:77], v5 offset:20480
    ds_read_b64_tr_b16 v[78:79], v5 offset:21504
    ds_read_b64_tr_b16 v[80:81], v6 offset:20480
    v_mfma_f32_32x32x16_bf16 v[32:47], v[56:59], v[48:51], v[32:47]
    ds_read_b64_tr_b16 v[82:83], v6 offset:21504
    ds_read_b128 v[84:87], v4 offset:52224
    ds_read_b64_tr_b16 v[88:89], v5 offset:22528
    v_mfma_f32_32x32x16_bf16 v[16:31], v[64:67], v[60:63], v[16:31]
    ds_read_b64_tr_b16 v[90:91], v5 offset:23552
    ds_read_b64_tr_b16 v[92:93], v6 offset:22528
    ds_read_b64_tr_b16 v[94:95], v6 offset:23552
    v_mfma_f32_32x32x16_bf16 v[32:47], v[68:71], v[60:63], v[32:47]
    s_waitcnt vmcnt(10) lgkmcnt(0)
    s_barrier
    v_mfma_f32_32x32x16_bf16 v[16:31], v[76:79], v[72:75], v[16:31]
    ds_read_b128 v[48:51], v4 offset:0
    ds_read_b64_tr_b16 v[52:53], v7 offset:0
    ds_read_b64_tr_b16 v[54:55], v7 offset:1024
    ds_read_b64_tr_b16 v[56:57], v8 offset:0
    v_mfma_f32_32x32x16_bf16 v[32:47], v[80:83], v[72:75], v[32:47]
    ds_read_b64_tr_b16 v[58:59], v8 offset:1024
    ds_read_b128 v[60:63], v4 offset:1024
    ds_read_b64_tr_b16 v[64:65], v7 offset:2048
    v_mfma_f32_32x32x16_bf16 v[16:31], v[88:91], v[84:87], v[16:31]
    ds_read_b64_tr_b16 v[66:67], v7 offset:3072
    ds_read_b64_tr_b16 v[68:69], v8 offset:2048
    ds_read_b64_tr_b16 v[70:71], v8 offset:3072
    v_mfma_f32_32x32x16_bf16 v[32:47], v[92:95], v[84:87], v[32:47]
    s_add_u32 m0, s49, 114688
    s_add_u32 s32, s30, 45056
    buffer_load_dwordx4 v2, s[4:7], s32 offen sc1 lds
    buffer_load_dwordx4 v2, s[4:7], s32 offen offset:1024 sc1 lds
    s_add_u32 m0, s49, 16384
    s_add_u32 s32, s48, 1703936
    buffer_load_dwordx4 v244, s[16:19], s32 offen lds
    s_add_u32 m0, s49, 17408
    s_add_u32 s32, s48, 1720320
    buffer_load_dwordx4 v244, s[16:19], s32 offen lds
    s_waitcnt lgkmcnt(0)
    v_mfma_f32_32x32x16_bf16 v[16:31], v[52:55], v[48:51], v[16:31]
    ds_read_b128 v[72:75], v4 offset:2048
    ds_read_b64_tr_b16 v[76:77], v7 offset:4096
    ds_read_b64_tr_b16 v[78:79], v7 offset:5120
    ds_read_b64_tr_b16 v[80:81], v8 offset:4096
    v_mfma_f32_32x32x16_bf16 v[32:47], v[56:59], v[48:51], v[32:47]
    ds_read_b64_tr_b16 v[82:83], v8 offset:5120
    ds_read_b128 v[84:87], v4 offset:3072
    ds_read_b64_tr_b16 v[88:89], v7 offset:6144
    v_mfma_f32_32x32x16_bf16 v[16:31], v[64:67], v[60:63], v[16:31]
    ds_read_b64_tr_b16 v[90:91], v7 offset:7168
    ds_read_b64_tr_b16 v[92:93], v8 offset:6144
    ds_read_b64_tr_b16 v[94:95], v8 offset:7168
    v_mfma_f32_32x32x16_bf16 v[32:47], v[68:71], v[60:63], v[32:47]
    s_waitcnt vmcnt(10) lgkmcnt(0)
    s_barrier
    v_mfma_f32_32x32x16_bf16 v[16:31], v[76:79], v[72:75], v[16:31]
    ds_read_b128 v[48:51], v4 offset:16384
    ds_read_b64_tr_b16 v[52:53], v7 offset:16384
    ds_read_b64_tr_b16 v[54:55], v7 offset:17408
    ds_read_b64_tr_b16 v[56:57], v8 offset:16384
    v_mfma_f32_32x32x16_bf16 v[32:47], v[80:83], v[72:75], v[32:47]
    ds_read_b64_tr_b16 v[58:59], v8 offset:17408
    ds_read_b128 v[60:63], v4 offset:17408
    ds_read_b64_tr_b16 v[64:65], v7 offset:18432
    v_mfma_f32_32x32x16_bf16 v[16:31], v[88:91], v[84:87], v[16:31]
    ds_read_b64_tr_b16 v[66:67], v7 offset:19456
    ds_read_b64_tr_b16 v[68:69], v8 offset:18432
    ds_read_b64_tr_b16 v[70:71], v8 offset:19456
    v_mfma_f32_32x32x16_bf16 v[32:47], v[92:95], v[84:87], v[32:47]
    s_add_u32 m0, s49, 65536
    s_add_u32 s32, s30, 49152
    buffer_load_dwordx4 v2, s[4:7], s32 offen sc1 lds
    buffer_load_dwordx4 v2, s[4:7], s32 offen offset:1024 sc1 lds
    s_add_u32 m0, s49, 131072
    s_add_u32 s32, s48, 1835008
    buffer_load_dwordx4 v244, s[16:19], s32 offen lds
    s_add_u32 m0, s49, 132096
    s_add_u32 s32, s48, 1851392
    buffer_load_dwordx4 v244, s[16:19], s32 offen lds
    s_waitcnt lgkmcnt(0)
    v_mfma_f32_32x32x16_bf16 v[16:31], v[52:55], v[48:51], v[16:31]
    ds_read_b128 v[72:75], v4 offset:18432
    ds_read_b64_tr_b16 v[76:77], v7 offset:20480
    ds_read_b64_tr_b16 v[78:79], v7 offset:21504
    ds_read_b64_tr_b16 v[80:81], v8 offset:20480
    v_mfma_f32_32x32x16_bf16 v[32:47], v[56:59], v[48:51], v[32:47]
    ds_read_b64_tr_b16 v[82:83], v8 offset:21504
    ds_read_b128 v[84:87], v4 offset:19456
    ds_read_b64_tr_b16 v[88:89], v7 offset:22528
    v_mfma_f32_32x32x16_bf16 v[16:31], v[64:67], v[60:63], v[16:31]
    ds_read_b64_tr_b16 v[90:91], v7 offset:23552
    ds_read_b64_tr_b16 v[92:93], v8 offset:22528
    ds_read_b64_tr_b16 v[94:95], v8 offset:23552
    v_mfma_f32_32x32x16_bf16 v[32:47], v[68:71], v[60:63], v[32:47]
    s_waitcnt vmcnt(10) lgkmcnt(0)
    s_barrier
    v_mfma_f32_32x32x16_bf16 v[16:31], v[76:79], v[72:75], v[16:31]
    ds_read_b128 v[48:51], v4 offset:32768
    ds_read_b64_tr_b16 v[52:53], v5 offset:32768
    ds_read_b64_tr_b16 v[54:55], v5 offset:33792
    ds_read_b64_tr_b16 v[56:57], v6 offset:32768
    v_mfma_f32_32x32x16_bf16 v[32:47], v[80:83], v[72:75], v[32:47]
    ds_read_b64_tr_b16 v[58:59], v6 offset:33792
    ds_read_b128 v[60:63], v4 offset:33792
    ds_read_b64_tr_b16 v[64:65], v5 offset:34816
    v_mfma_f32_32x32x16_bf16 v[16:31], v[88:91], v[84:87], v[16:31]
    ds_read_b64_tr_b16 v[66:67], v5 offset:35840
    ds_read_b64_tr_b16 v[68:69], v6 offset:34816
    ds_read_b64_tr_b16 v[70:71], v6 offset:35840
    v_mfma_f32_32x32x16_bf16 v[32:47], v[92:95], v[84:87], v[32:47]
    s_add_u32 m0, s49, 81920
    s_add_u32 s32, s30, 53248
    buffer_load_dwordx4 v2, s[4:7], s32 offen sc1 lds
    buffer_load_dwordx4 v2, s[4:7], s32 offen offset:1024 sc1 lds
    s_add_u32 m0, s49, 147456
    s_add_u32 s32, s48, 1966080
    buffer_load_dwordx4 v244, s[16:19], s32 offen lds
    s_add_u32 m0, s49, 148480
    s_add_u32 s32, s48, 1982464
    buffer_load_dwordx4 v244, s[16:19], s32 offen lds
    s_waitcnt lgkmcnt(0)
    v_mfma_f32_32x32x16_bf16 v[16:31], v[52:55], v[48:51], v[16:31]
    ds_read_b128 v[72:75], v4 offset:34816
    ds_read_b64_tr_b16 v[76:77], v5 offset:36864
    ds_read_b64_tr_b16 v[78:79], v5 offset:37888
    ds_read_b64_tr_b16 v[80:81], v6 offset:36864
    v_mfma_f32_32x32x16_bf16 v[32:47], v[56:59], v[48:51], v[32:47]
    ds_read_b64_tr_b16 v[82:83], v6 offset:37888
    ds_read_b128 v[84:87], v4 offset:35840
    ds_read_b64_tr_b16 v[88:89], v5 offset:38912
    v_mfma_f32_32x32x16_bf16 v[16:31], v[64:67], v[60:63], v[16:31]
    ds_read_b64_tr_b16 v[90:91], v5 offset:39936
    ds_read_b64_tr_b16 v[92:93], v6 offset:38912
    ds_read_b64_tr_b16 v[94:95], v6 offset:39936
    v_mfma_f32_32x32x16_bf16 v[32:47], v[68:71], v[60:63], v[32:47]
    s_waitcnt vmcnt(10) lgkmcnt(0)
    s_barrier
    v_mfma_f32_32x32x16_bf16 v[16:31], v[76:79], v[72:75], v[16:31]
    ds_read_b128 v[48:51], v4 offset:49152
    ds_read_b64_tr_b16 v[52:53], v5 offset:49152
    ds_read_b64_tr_b16 v[54:55], v5 offset:50176
    ds_read_b64_tr_b16 v[56:57], v6 offset:49152
    v_mfma_f32_32x32x16_bf16 v[32:47], v[80:83], v[72:75], v[32:47]
    ds_read_b64_tr_b16 v[58:59], v6 offset:50176
    ds_read_b128 v[60:63], v4 offset:50176
    ds_read_b64_tr_b16 v[64:65], v5 offset:51200
    v_mfma_f32_32x32x16_bf16 v[16:31], v[88:91], v[84:87], v[16:31]
    ds_read_b64_tr_b16 v[66:67], v5 offset:52224
    ds_read_b64_tr_b16 v[68:69], v6 offset:51200
    ds_read_b64_tr_b16 v[70:71], v6 offset:52224
    v_mfma_f32_32x32x16_bf16 v[32:47], v[92:95], v[84:87], v[32:47]
    s_add_u32 m0, s49, 98304
    s_add_u32 s32, s30, 57344
    buffer_load_dwordx4 v2, s[4:7], s32 offen sc1 lds
    buffer_load_dwordx4 v2, s[4:7], s32 offen offset:1024 sc1 lds
    s_waitcnt lgkmcnt(0)
    v_mfma_f32_32x32x16_bf16 v[16:31], v[52:55], v[48:51], v[16:31]
    ds_read_b128 v[72:75], v4 offset:51200
    ds_read_b64_tr_b16 v[76:77], v5 offset:53248
    ds_read_b64_tr_b16 v[78:79], v5 offset:54272
    ds_read_b64_tr_b16 v[80:81], v6 offset:53248
    v_mfma_f32_32x32x16_bf16 v[32:47], v[56:59], v[48:51], v[32:47]
    ds_read_b64_tr_b16 v[82:83], v6 offset:54272
    ds_read_b128 v[84:87], v4 offset:52224
    ds_read_b64_tr_b16 v[88:89], v5 offset:55296
    v_mfma_f32_32x32x16_bf16 v[16:31], v[64:67], v[60:63], v[16:31]
    ds_read_b64_tr_b16 v[90:91], v5 offset:56320
    ds_read_b64_tr_b16 v[92:93], v6 offset:55296
    ds_read_b64_tr_b16 v[94:95], v6 offset:56320
    v_mfma_f32_32x32x16_bf16 v[32:47], v[68:71], v[60:63], v[32:47]
    s_waitcnt vmcnt(8) lgkmcnt(0)
    s_barrier
    v_mfma_f32_32x32x16_bf16 v[16:31], v[76:79], v[72:75], v[16:31]
    ds_read_b128 v[48:51], v4 offset:0
    ds_read_b64_tr_b16 v[52:53], v5 offset:0
    ds_read_b64_tr_b16 v[54:55], v5 offset:1024
    ds_read_b64_tr_b16 v[56:57], v6 offset:0
    v_mfma_f32_32x32x16_bf16 v[32:47], v[80:83], v[72:75], v[32:47]
    ds_read_b64_tr_b16 v[58:59], v6 offset:1024
    ds_read_b128 v[60:63], v4 offset:1024
    ds_read_b64_tr_b16 v[64:65], v5 offset:2048
    v_mfma_f32_32x32x16_bf16 v[16:31], v[88:91], v[84:87], v[16:31]
    ds_read_b64_tr_b16 v[66:67], v5 offset:3072
    ds_read_b64_tr_b16 v[68:69], v6 offset:2048
    ds_read_b64_tr_b16 v[70:71], v6 offset:3072
    v_mfma_f32_32x32x16_bf16 v[32:47], v[92:95], v[84:87], v[32:47]
    s_add_u32 m0, s49, 114688
    s_add_u32 s32, s30, 61440
    buffer_load_dwordx4 v2, s[4:7], s32 offen sc1 lds
    buffer_load_dwordx4 v2, s[4:7], s32 offen offset:1024 sc1 lds
    s_waitcnt lgkmcnt(0)
    v_mfma_f32_32x32x16_bf16 v[16:31], v[52:55], v[48:51], v[16:31]
    ds_read_b128 v[72:75], v4 offset:2048
    ds_read_b64_tr_b16 v[76:77], v5 offset:4096
    ds_read_b64_tr_b16 v[78:79], v5 offset:5120
    ds_read_b64_tr_b16 v[80:81], v6 offset:4096
    v_mfma_f32_32x32x16_bf16 v[32:47], v[56:59], v[48:51], v[32:47]
    ds_read_b64_tr_b16 v[82:83], v6 offset:5120
    ds_read_b128 v[84:87], v4 offset:3072
    ds_read_b64_tr_b16 v[88:89], v5 offset:6144
    v_mfma_f32_32x32x16_bf16 v[16:31], v[64:67], v[60:63], v[16:31]
    ds_read_b64_tr_b16 v[90:91], v5 offset:7168
    ds_read_b64_tr_b16 v[92:93], v6 offset:6144
    ds_read_b64_tr_b16 v[94:95], v6 offset:7168
    v_mfma_f32_32x32x16_bf16 v[32:47], v[68:71], v[60:63], v[32:47]
    s_waitcnt vmcnt(6) lgkmcnt(0)
    s_barrier
    v_mfma_f32_32x32x16_bf16 v[16:31], v[76:79], v[72:75], v[16:31]
    ds_read_b128 v[48:51], v4 offset:16384
    ds_read_b64_tr_b16 v[52:53], v5 offset:16384
    ds_read_b64_tr_b16 v[54:55], v5 offset:17408
    ds_read_b64_tr_b16 v[56:57], v6 offset:16384
    v_mfma_f32_32x32x16_bf16 v[32:47], v[80:83], v[72:75], v[32:47]
    ds_read_b64_tr_b16 v[58:59], v6 offset:17408
    ds_read_b128 v[60:63], v4 offset:17408
    ds_read_b64_tr_b16 v[64:65], v5 offset:18432
    v_mfma_f32_32x32x16_bf16 v[16:31], v[88:91], v[84:87], v[16:31]
    ds_read_b64_tr_b16 v[66:67], v5 offset:19456
    ds_read_b64_tr_b16 v[68:69], v6 offset:18432
    ds_read_b64_tr_b16 v[70:71], v6 offset:19456
    v_mfma_f32_32x32x16_bf16 v[32:47], v[92:95], v[84:87], v[32:47]
    s_waitcnt lgkmcnt(0)
    v_mfma_f32_32x32x16_bf16 v[16:31], v[52:55], v[48:51], v[16:31]
    ds_read_b128 v[72:75], v4 offset:18432
    ds_read_b64_tr_b16 v[76:77], v5 offset:20480
    ds_read_b64_tr_b16 v[78:79], v5 offset:21504
    ds_read_b64_tr_b16 v[80:81], v6 offset:20480
    v_mfma_f32_32x32x16_bf16 v[32:47], v[56:59], v[48:51], v[32:47]
    ds_read_b64_tr_b16 v[82:83], v6 offset:21504
    ds_read_b128 v[84:87], v4 offset:19456
    ds_read_b64_tr_b16 v[88:89], v5 offset:22528
    v_mfma_f32_32x32x16_bf16 v[16:31], v[64:67], v[60:63], v[16:31]
    ds_read_b64_tr_b16 v[90:91], v5 offset:23552
    ds_read_b64_tr_b16 v[92:93], v6 offset:22528
    ds_read_b64_tr_b16 v[94:95], v6 offset:23552
    v_mfma_f32_32x32x16_bf16 v[32:47], v[68:71], v[60:63], v[32:47]
    s_waitcnt vmcnt(2) lgkmcnt(0)
    s_barrier
    v_mfma_f32_32x32x16_bf16 v[16:31], v[76:79], v[72:75], v[16:31]
    ds_read_b128 v[48:51], v4 offset:32768
    ds_read_b64_tr_b16 v[52:53], v7 offset:0
    ds_read_b64_tr_b16 v[54:55], v7 offset:1024
    ds_read_b64_tr_b16 v[56:57], v8 offset:0
    v_mfma_f32_32x32x16_bf16 v[32:47], v[80:83], v[72:75], v[32:47]
    ds_read_b64_tr_b16 v[58:59], v8 offset:1024
    ds_read_b128 v[60:63], v4 offset:33792
    ds_read_b64_tr_b16 v[64:65], v7 offset:2048
    v_mfma_f32_32x32x16_bf16 v[16:31], v[88:91], v[84:87], v[16:31]
    ds_read_b64_tr_b16 v[66:67], v7 offset:3072
    ds_read_b64_tr_b16 v[68:69], v8 offset:2048
    ds_read_b64_tr_b16 v[70:71], v8 offset:3072
    v_mfma_f32_32x32x16_bf16 v[32:47], v[92:95], v[84:87], v[32:47]
    s_waitcnt lgkmcnt(0)
    v_mfma_f32_32x32x16_bf16 v[16:31], v[52:55], v[48:51], v[16:31]
    ds_read_b128 v[72:75], v4 offset:34816
    ds_read_b64_tr_b16 v[76:77], v7 offset:4096
    ds_read_b64_tr_b16 v[78:79], v7 offset:5120
    ds_read_b64_tr_b16 v[80:81], v8 offset:4096
    v_mfma_f32_32x32x16_bf16 v[32:47], v[56:59], v[48:51], v[32:47]
    ds_read_b64_tr_b16 v[82:83], v8 offset:5120
    ds_read_b128 v[84:87], v4 offset:35840
    ds_read_b64_tr_b16 v[88:89], v7 offset:6144
    v_mfma_f32_32x32x16_bf16 v[16:31], v[64:67], v[60:63], v[16:31]
    ds_read_b64_tr_b16 v[90:91], v7 offset:7168
    ds_read_b64_tr_b16 v[92:93], v8 offset:6144
    ds_read_b64_tr_b16 v[94:95], v8 offset:7168
    v_mfma_f32_32x32x16_bf16 v[32:47], v[68:71], v[60:63], v[32:47]
    s_waitcnt vmcnt(0) lgkmcnt(0)
    s_barrier
    v_mfma_f32_32x32x16_bf16 v[16:31], v[76:79], v[72:75], v[16:31]
    ds_read_b128 v[48:51], v4 offset:49152
    ds_read_b64_tr_b16 v[52:53], v7 offset:16384
    ds_read_b64_tr_b16 v[54:55], v7 offset:17408
    ds_read_b64_tr_b16 v[56:57], v8 offset:16384
    v_mfma_f32_32x32x16_bf16 v[32:47], v[80:83], v[72:75], v[32:47]
    ds_read_b64_tr_b16 v[58:59], v8 offset:17408
    ds_read_b128 v[60:63], v4 offset:50176
    ds_read_b64_tr_b16 v[64:65], v7 offset:18432
    v_mfma_f32_32x32x16_bf16 v[16:31], v[88:91], v[84:87], v[16:31]
    ds_read_b64_tr_b16 v[66:67], v7 offset:19456
    ds_read_b64_tr_b16 v[68:69], v8 offset:18432
    ds_read_b64_tr_b16 v[70:71], v8 offset:19456
    v_mfma_f32_32x32x16_bf16 v[32:47], v[92:95], v[84:87], v[32:47]
    s_waitcnt lgkmcnt(0)
    v_mfma_f32_32x32x16_bf16 v[16:31], v[52:55], v[48:51], v[16:31]
    ds_read_b128 v[72:75], v4 offset:51200
    ds_read_b64_tr_b16 v[76:77], v7 offset:20480
    ds_read_b64_tr_b16 v[78:79], v7 offset:21504
    ds_read_b64_tr_b16 v[80:81], v8 offset:20480
    v_mfma_f32_32x32x16_bf16 v[32:47], v[56:59], v[48:51], v[32:47]
    ds_read_b64_tr_b16 v[82:83], v8 offset:21504
    ds_read_b128 v[84:87], v4 offset:52224
    ds_read_b64_tr_b16 v[88:89], v7 offset:22528
    v_mfma_f32_32x32x16_bf16 v[16:31], v[64:67], v[60:63], v[16:31]
    ds_read_b64_tr_b16 v[90:91], v7 offset:23552
    ds_read_b64_tr_b16 v[92:93], v8 offset:22528
    ds_read_b64_tr_b16 v[94:95], v8 offset:23552
    v_mfma_f32_32x32x16_bf16 v[32:47], v[68:71], v[60:63], v[32:47]
    s_waitcnt lgkmcnt(0)
    v_mfma_f32_32x32x16_bf16 v[16:31], v[76:79], v[72:75], v[16:31]
    v_mfma_f32_32x32x16_bf16 v[32:47], v[80:83], v[72:75], v[32:47]
    v_mfma_f32_32x32x16_bf16 v[16:31], v[88:91], v[84:87], v[16:31]
    v_mfma_f32_32x32x16_bf16 v[32:47], v[92:95], v[84:87], v[32:47]
    v_and_b32 v9, 31, v1
    v_lshrrev_b32 v10, 5, v1
    v_lshlrev_b32 v10, 2, v10
    v_and_b32 v11, 7, v1
    v_xor_b32 v10, v10, v11
    v_lshlrev_b32 v10, 4, v10
    v_lshl_add_u32 v10, v9, 7, v10
    s_lshl_b32 s33, s22, 12
    s_add_u32 s33, s33, 81920
    v_add_u32 v10, s33, v10
    v_lshrrev_b32 v9, 3, v1
    v_xor_b32 v12, v9, v11
    v_lshlrev_b32 v12, 4, v12
    v_lshl_add_u32 v12, v9, 7, v12
    v_add_u32 v12, s33, v12
    v_lshlrev_b32 v11, 4, v11
    v_lshl_add_u32 v11, v9, 12, v11
    v_xor_b32 v13, 16, v10
    v_xor_b32 v14, 32, v10
    v_xor_b32 v15, 48, v10
    s_lshl_b32 s32, s21, 19
    s_lshl_b32 s33, s25, 17
    s_add_u32 s32, s32, s33
    s_lshl_b32 s33, s20, 11
    s_add_u32 s32, s32, s33
    s_lshl_b32 s33, s24, 8
    s_add_u32 s32, s32, s33
    s_lshl_b32 s33, s26, 7
    s_add_u32 s32, s32, s33
    v_cvt_pk_bf16_f32 v48, v16, v17
    v_cvt_pk_bf16_f32 v49, v18, v19
    v_cvt_pk_bf16_f32 v50, v20, v21
    v_cvt_pk_bf16_f32 v51, v22, v23
    ds_write_b128 v10, v[48:51]
    v_cvt_pk_bf16_f32 v52, v24, v25
    v_cvt_pk_bf16_f32 v53, v26, v27
    v_cvt_pk_bf16_f32 v54, v28, v29
    v_cvt_pk_bf16_f32 v55, v30, v31
    ds_write_b128 v13, v[52:55]
    v_cvt_pk_bf16_f32 v56, v32, v33
    v_cvt_pk_bf16_f32 v57, v34, v35
    v_cvt_pk_bf16_f32 v58, v36, v37
    v_cvt_pk_bf16_f32 v59, v38, v39
    ds_write_b128 v14, v[56:59]
    v_cvt_pk_bf16_f32 v60, v40, v41
    v_cvt_pk_bf16_f32 v61, v42, v43
    v_cvt_pk_bf16_f32 v62, v44, v45
    v_cvt_pk_bf16_f32 v63, v46, v47
    ds_write_b128 v15, v[60:63]
    ds_read_b128 v[64:67], v12 offset:0
    ds_read_b128 v[68:71], v12 offset:1024
    ds_read_b128 v[72:75], v12 offset:2048
    ds_read_b128 v[76:79], v12 offset:3072
    s_waitcnt lgkmcnt(3)
    buffer_store_dwordx4 v[64:67], v11, s[12:15], s32 offen
    s_add_u32 s32, s32, 32768
    s_waitcnt lgkmcnt(2)
    buffer_store_dwordx4 v[68:71], v11, s[12:15], s32 offen
    s_add_u32 s32, s32, 32768
    s_waitcnt lgkmcnt(1)
    buffer_store_dwordx4 v[72:75], v11, s[12:15], s32 offen
    s_add_u32 s32, s32, 32768
    s_waitcnt lgkmcnt(0)
    buffer_store_dwordx4 v[76:79], v11, s[12:15], s32 offen
K1_END:
    s_endpgm
CODE_END:
.section .rodata,"a"
.p2align 6
.amdhsa_kernel concat_heads__softmax_full_mha__linear_kernel_hedgehog__prompt_kernel
  .amdhsa_next_free_vgpr 256
  .amdhsa_next_free_sgpr 100
  .amdhsa_accum_offset 256
  .amdhsa_group_segment_fixed_size 0
  .amdhsa_kernarg_size 80
  .amdhsa_user_sgpr_count 2
  .amdhsa_user_sgpr_kernarg_segment_ptr 1
  .amdhsa_system_sgpr_workgroup_id_x 1
.end_amdhsa_kernel
```
